```python
import torch

def _softmax(x, axis=-1):
    return torch.softmax(x, dim=axis)
def _gelu(x):
    return torch.nn.functional.gelu(x, approximate="tanh")
def _silu(x):
    return torch.nn.functional.silu(x)
def _sigmoid(x):
    return torch.sigmoid(x)
def _layernorm(x, axis=-1, eps=1e-5):
    m = x.mean(dim=axis, keepdim=True)
    v = x.var(dim=axis, keepdim=True, unbiased=False)
    return (x - m) / torch.sqrt(v + eps)
def _scatter_add(tgt, idx, src, axis=0):
    return tgt.clone().index_add_(axis, idx, src)
def _segment_sum(src, seg, n):
    out = torch.zeros((n,) + src.shape[1:], dtype=src.dtype)
    return out.index_add_(0, seg, src)
def _pad(x, pw):
    flat = tuple(v for pair in reversed(pw) for v in pair)
    return torch.nn.functional.pad(x, flat)

kernel_name = 'standalone__gqa_block_cached__near_ridge'

def setup_inputs():

    _w = (lambda a: (lambda t: t.to(torch.bfloat16) if t.is_floating_point() else t)(torch.as_tensor(a)))
    B, Sq, D = 8, 144, 512
    Hq, Hkv, Sk, Dh = 32, 32, 1024, 128
    assert Hq % Hkv == 0, (Hq, Hkv)
    return {
        "x": _w((lambda *s: torch.randn(*s, dtype=torch.bfloat16) * 0.8)(B, Sq, D)),
        "k_cache": _w((lambda *s: torch.randn(*s, dtype=torch.bfloat16) * 0.8)(B, Hkv, Sk, Dh)),
        "v_cache": _w((lambda *s: torch.randn(*s, dtype=torch.bfloat16) * 0.05)(B, Hkv, Sk, Dh)),
        "wq": _w((lambda *s: torch.randn(*s, dtype=torch.bfloat16) * 0.8)(D, Hq * Dh) * (D ** -0.5)),
        "wo": _w((lambda *s: torch.randn(*s, dtype=torch.bfloat16) * 0.05)(Hq * Dh, D) * ((Hq * Dh) ** -0.5)),
    }

def reference(x, k_cache, v_cache, wq, wo):
    B, Sq, D = x.shape
    Hq, Dh = 32, 128
    Hkv = k_cache.shape[1]
    rep = Hq // Hkv
    q = (lambda x, *d: x.permute(*d))((x @ wq).reshape(B, Sq, Hq, Dh), 0, 2, 1, 3)
    k = (lambda x, n, axis: torch.repeat_interleave(x, n, dim=axis))(k_cache, rep, axis=1)
    v = (lambda x, n, axis: torch.repeat_interleave(x, n, dim=axis))(v_cache, rep, axis=1)
    scores = torch.einsum("bhqd,bhkd->bhqk", q, k) * (Dh ** -0.5)
    p = _softmax(scores, axis=-1)
    o = torch.einsum("bhqk,bhkd->bhqd", p, v)
    return (lambda x, *d: x.permute(*d))(o, 0, 2, 1, 3).reshape(B, Sq, Hq * Dh) @ wo
```

```asm
; @launch kernel=attn_kernel grid=(256,1,1) block=(256,1,1) lds=163840
; @launch kernel=oproj_kernel grid=(256,1,1) block=(256,1,1) lds=131072
; @launch kernel=ored_kernel grid=(576,1,1) block=(256,1,1) lds=0
.amdgcn_target "amdgcn-amd-amdhsa--gfx950"
.text
.globl attn_kernel
.p2align 8
.type attn_kernel,@function
attn_kernel:
    s_cmp_ge_u32 s2, 256
    s_cbranch_scc1 A_END
    s_load_dwordx8 s[4:11], s[0:1], 0
    s_load_dwordx2 s[12:13], s[0:1], 56
    s_load_dwordx2 s[84:85], s[0:1], 32
    s_lshr_b32 s14, s2, 5
    s_and_b32 s15, s2, 7
    s_lshl_b32 s15, s15, 2
    s_lshr_b32 s17, s2, 3
    s_and_b32 s17, s17, 3
    s_or_b32 s15, s15, s17
    v_lshrrev_b32 v1, 6, v0
    v_and_b32 v0, 63, v0
    s_nop 0
    v_readfirstlane_b32 s16, v1
    s_waitcnt lgkmcnt(0)
    s_mul_i32 s17, s14, 147456
    s_add_u32 s20, s4, s17
    s_addc_u32 s21, s5, 0
    s_and_b32 s21, s21, 0xffff
    s_mov_b32 s22, 147456
    s_mov_b32 s23, 0x00020000
    s_lshl_b32 s17, s14, 5
    s_add_u32 s17, s17, s15
    s_lshl_b32 s17, s17, 18
    s_add_u32 s24, s6, s17
    s_addc_u32 s25, s7, 0
    s_and_b32 s25, s25, 0xffff
    s_mov_b32 s26, 262144
    s_mov_b32 s27, 0x00020000
    s_add_u32 s28, s8, s17
    s_addc_u32 s29, s9, 0
    s_and_b32 s29, s29, 0xffff
    s_mov_b32 s30, 262144
    s_mov_b32 s31, 0x00020000
    s_lshl_b32 s17, s15, 8
    s_sub_u32 s18, 4194304, s17
    s_add_u32 s32, s10, s17
    s_addc_u32 s33, s11, 0
    s_and_b32 s33, s33, 0xffff
    s_mov_b32 s34, s18
    s_mov_b32 s35, 0x00020000
    s_mul_i32 s18, s14, 1179648
    s_lshl_b32 s17, s15, 12
    s_add_u32 s18, s18, s17
    s_sub_u32 s19, 1179648, s17
    s_add_u32 s36, s12, s18
    s_addc_u32 s37, s13, 0
    s_and_b32 s37, s37, 0xffff
    s_mov_b32 s38, s19
    s_mov_b32 s39, 0x00020000
    s_lshl_b32 s46, s14, 1
    s_and_b32 s47, s15, 3
    s_mul_i32 s47, s47, 5
    s_add_u32 s46, s46, s47
    v_lshrrev_b32 v1, 4, v0
    v_and_b32 v2, 15, v0
    s_cmp_eq_u32 s16, 3
    s_cbranch_scc1 A_LOADER
    s_mul_i32 s17, s16, 49152
    v_lshrrev_b32 v4, 2, v0
    v_lshlrev_b32 v4, 10, v4
    v_and_b32 v5, 3, v0
    v_lshl_add_u32 v4, v5, 4, v4
    v_add_u32 v10, s17, v4
    v_add_u32 v11, 16384, v10
    v_add_u32 v12, 32768, v10
    s_add_u32 s47, s46, 0
    s_and_b32 s47, s47, 15
    s_lshl_b32 s47, s47, 6
    buffer_load_dwordx4 v[64:67], v10, s[20:23], s47 offen
    buffer_load_dwordx4 v[68:71], v11, s[20:23], s47 offen
    buffer_load_dwordx4 v[72:75], v12, s[20:23], s47 offen
    s_add_u32 s47, s46, 1
    s_and_b32 s47, s47, 15
    s_lshl_b32 s47, s47, 6
    buffer_load_dwordx4 v[76:79], v10, s[20:23], s47 offen
    buffer_load_dwordx4 v[80:83], v11, s[20:23], s47 offen
    buffer_load_dwordx4 v[84:87], v12, s[20:23], s47 offen
    s_add_u32 s47, s46, 2
    s_and_b32 s47, s47, 15
    s_lshl_b32 s47, s47, 6
    buffer_load_dwordx4 v[88:91], v10, s[20:23], s47 offen
    buffer_load_dwordx4 v[92:95], v11, s[20:23], s47 offen
    buffer_load_dwordx4 v[96:99], v12, s[20:23], s47 offen
    s_add_u32 s47, s46, 3
    s_and_b32 s47, s47, 15
    s_lshl_b32 s47, s47, 6
    buffer_load_dwordx4 v[100:103], v10, s[20:23], s47 offen
    buffer_load_dwordx4 v[104:107], v11, s[20:23], s47 offen
    buffer_load_dwordx4 v[108:111], v12, s[20:23], s47 offen
    v_lshlrev_b32 v13, 4, v2
    v_lshl_add_u32 v13, v1, 2, v13
    v_lshrrev_b32 v5, 2, v2
    v_and_b32 v6, 3, v2
    v_lshl_add_u32 v7, v1, 3, v5
    v_lshlrev_b32 v7, 8, v7
    v_lshl_add_u32 v7, v6, 6, v7
    v_add_u32 v7, 98304, v7
    v_xor_b32 v9, 0, v5
    v_lshl_add_u32 v56, v9, 4, v7
    v_xor_b32 v9, 1, v5
    v_lshl_add_u32 v57, v9, 4, v7
    v_xor_b32 v9, 2, v5
    v_lshl_add_u32 v58, v9, 4, v7
    v_xor_b32 v9, 3, v5
    v_lshl_add_u32 v59, v9, 4, v7
    v_accvgpr_write_b32 a0, 0
    v_accvgpr_write_b32 a1, 0
    v_accvgpr_write_b32 a2, 0
    v_accvgpr_write_b32 a3, 0
    v_accvgpr_write_b32 a4, 0
    v_accvgpr_write_b32 a5, 0
    v_accvgpr_write_b32 a6, 0
    v_accvgpr_write_b32 a7, 0
    v_accvgpr_write_b32 a8, 0
    v_accvgpr_write_b32 a9, 0
    v_accvgpr_write_b32 a10, 0
    v_accvgpr_write_b32 a11, 0
    v_accvgpr_write_b32 a12, 0
    v_accvgpr_write_b32 a13, 0
    v_accvgpr_write_b32 a14, 0
    v_accvgpr_write_b32 a15, 0
    v_accvgpr_write_b32 a16, 0
    v_accvgpr_write_b32 a17, 0
    v_accvgpr_write_b32 a18, 0
    v_accvgpr_write_b32 a19, 0
    v_accvgpr_write_b32 a20, 0
    v_accvgpr_write_b32 a21, 0
    v_accvgpr_write_b32 a22, 0
    v_accvgpr_write_b32 a23, 0
    v_accvgpr_write_b32 a24, 0
    v_accvgpr_write_b32 a25, 0
    v_accvgpr_write_b32 a26, 0
    v_accvgpr_write_b32 a27, 0
    v_accvgpr_write_b32 a28, 0
    v_accvgpr_write_b32 a29, 0
    v_accvgpr_write_b32 a30, 0
    v_accvgpr_write_b32 a31, 0
    v_accvgpr_write_b32 a32, 0
    v_accvgpr_write_b32 a33, 0
    v_accvgpr_write_b32 a34, 0
    v_accvgpr_write_b32 a35, 0
    v_accvgpr_write_b32 a36, 0
    v_accvgpr_write_b32 a37, 0
    v_accvgpr_write_b32 a38, 0
    v_accvgpr_write_b32 a39, 0
    v_accvgpr_write_b32 a40, 0
    v_accvgpr_write_b32 a41, 0
    v_accvgpr_write_b32 a42, 0
    v_accvgpr_write_b32 a43, 0
    v_accvgpr_write_b32 a44, 0
    v_accvgpr_write_b32 a45, 0
    v_accvgpr_write_b32 a46, 0
    v_accvgpr_write_b32 a47, 0
    v_accvgpr_write_b32 a48, 0
    v_accvgpr_write_b32 a49, 0
    v_accvgpr_write_b32 a50, 0
    v_accvgpr_write_b32 a51, 0
    v_accvgpr_write_b32 a52, 0
    v_accvgpr_write_b32 a53, 0
    v_accvgpr_write_b32 a54, 0
    v_accvgpr_write_b32 a55, 0
    v_accvgpr_write_b32 a56, 0
    v_accvgpr_write_b32 a57, 0
    v_accvgpr_write_b32 a58, 0
    v_accvgpr_write_b32 a59, 0
    v_accvgpr_write_b32 a60, 0
    v_accvgpr_write_b32 a61, 0
    v_accvgpr_write_b32 a62, 0
    v_accvgpr_write_b32 a63, 0
    v_accvgpr_write_b32 a64, 0
    v_accvgpr_write_b32 a65, 0
    v_accvgpr_write_b32 a66, 0
    v_accvgpr_write_b32 a67, 0
    v_accvgpr_write_b32 a68, 0
    v_accvgpr_write_b32 a69, 0
    v_accvgpr_write_b32 a70, 0
    v_accvgpr_write_b32 a71, 0
    v_accvgpr_write_b32 a72, 0
    v_accvgpr_write_b32 a73, 0
    v_accvgpr_write_b32 a74, 0
    v_accvgpr_write_b32 a75, 0
    v_accvgpr_write_b32 a76, 0
    v_accvgpr_write_b32 a77, 0
    v_accvgpr_write_b32 a78, 0
    v_accvgpr_write_b32 a79, 0
    v_accvgpr_write_b32 a80, 0
    v_accvgpr_write_b32 a81, 0
    v_accvgpr_write_b32 a82, 0
    v_accvgpr_write_b32 a83, 0
    v_accvgpr_write_b32 a84, 0
    v_accvgpr_write_b32 a85, 0
    v_accvgpr_write_b32 a86, 0
    v_accvgpr_write_b32 a87, 0
    v_accvgpr_write_b32 a88, 0
    v_accvgpr_write_b32 a89, 0
    v_accvgpr_write_b32 a90, 0
    v_accvgpr_write_b32 a91, 0
    v_accvgpr_write_b32 a92, 0
    v_accvgpr_write_b32 a93, 0
    v_accvgpr_write_b32 a94, 0
    v_accvgpr_write_b32 a95, 0
    v_mov_b32 v136, 0
    v_mov_b32 v137, 0
    v_mov_b32 v138, 0
    v_mov_b32 v139, 0
    v_mov_b32 v148, -1.0
    v_mov_b32 v154, 0xff800000
    v_mov_b32 v151, 0
    v_mov_b32 v140, 0
    v_mov_b32 v141, 0
    v_mov_b32 v142, 0
    v_mov_b32 v143, 0
    v_mov_b32 v149, -1.0
    v_mov_b32 v155, 0xff800000
    v_mov_b32 v152, 0
    v_mov_b32 v144, 0
    v_mov_b32 v145, 0
    v_mov_b32 v146, 0
    v_mov_b32 v147, 0
    v_mov_b32 v150, -1.0
    v_mov_b32 v156, 0xff800000
    v_mov_b32 v153, 0
    v_accvgpr_write_b32 a160, 0
    v_accvgpr_write_b32 a161, 0
    v_accvgpr_write_b32 a162, 0
    v_accvgpr_write_b32 a163, 0
    v_accvgpr_write_b32 a164, 0
    v_accvgpr_write_b32 a165, 0
    v_accvgpr_write_b32 a166, 0
    v_accvgpr_write_b32 a167, 0
    v_accvgpr_write_b32 a168, 0
    v_accvgpr_write_b32 a169, 0
    v_accvgpr_write_b32 a170, 0
    v_accvgpr_write_b32 a171, 0
    v_accvgpr_write_b32 a172, 0
    v_accvgpr_write_b32 a173, 0
    v_accvgpr_write_b32 a174, 0
    v_accvgpr_write_b32 a175, 0
    v_accvgpr_write_b32 a176, 0
    v_accvgpr_write_b32 a177, 0
    v_accvgpr_write_b32 a178, 0
    v_accvgpr_write_b32 a179, 0
    v_accvgpr_write_b32 a180, 0
    v_accvgpr_write_b32 a181, 0
    v_accvgpr_write_b32 a182, 0
    v_accvgpr_write_b32 a183, 0
    v_accvgpr_write_b32 a184, 0
    v_accvgpr_write_b32 a185, 0
    v_accvgpr_write_b32 a186, 0
    v_accvgpr_write_b32 a187, 0
    v_accvgpr_write_b32 a188, 0
    v_accvgpr_write_b32 a189, 0
    v_accvgpr_write_b32 a190, 0
    v_accvgpr_write_b32 a191, 0
    v_accvgpr_write_b32 a192, 0
    v_accvgpr_write_b32 a193, 0
    v_accvgpr_write_b32 a194, 0
    v_accvgpr_write_b32 a195, 0
    v_accvgpr_write_b32 a196, 0
    v_accvgpr_write_b32 a197, 0
    v_accvgpr_write_b32 a198, 0
    v_accvgpr_write_b32 a199, 0
    v_accvgpr_write_b32 a200, 0
    v_accvgpr_write_b32 a201, 0
    v_accvgpr_write_b32 a202, 0
    v_accvgpr_write_b32 a203, 0
    v_accvgpr_write_b32 a204, 0
    v_accvgpr_write_b32 a205, 0
    v_accvgpr_write_b32 a206, 0
    v_accvgpr_write_b32 a207, 0
    v_accvgpr_write_b32 a208, 0
    v_accvgpr_write_b32 a209, 0
    v_accvgpr_write_b32 a210, 0
    v_accvgpr_write_b32 a211, 0
    v_accvgpr_write_b32 a212, 0
    v_accvgpr_write_b32 a213, 0
    v_accvgpr_write_b32 a214, 0
    v_accvgpr_write_b32 a215, 0
    v_accvgpr_write_b32 a216, 0
    v_accvgpr_write_b32 a217, 0
    v_accvgpr_write_b32 a218, 0
    v_accvgpr_write_b32 a219, 0
    v_accvgpr_write_b32 a220, 0
    v_accvgpr_write_b32 a221, 0
    v_accvgpr_write_b32 a222, 0
    v_accvgpr_write_b32 a223, 0
    v_and_b32 v5, 3, v2
    v_lshlrev_b32 v5, 2, v5
    v_lshrrev_b32 v6, 2, v2
    v_or_b32 v5, v5, v6
    v_lshlrev_b32 v6, 2, v1
    v_xor_b32 v5, v5, v6
    v_xor_b32 v6, 0, v5
    v_lshlrev_b32 v6, 4, v6
    v_lshl_add_u32 v172, v2, 8, v6
    v_xor_b32 v6, 1, v5
    v_lshlrev_b32 v6, 4, v6
    v_lshl_add_u32 v173, v2, 8, v6
    v_xor_b32 v6, 2, v5
    v_lshlrev_b32 v6, 4, v6
    v_lshl_add_u32 v174, v2, 8, v6
    v_xor_b32 v6, 3, v5
    v_lshlrev_b32 v6, 4, v6
    v_lshl_add_u32 v175, v2, 8, v6
    v_lshrrev_b32 v5, 2, v2
    v_and_b32 v6, 3, v2
    v_lshl_add_u32 v7, v1, 2, v5
    v_and_b32 v8, 7, v7
    v_lshlrev_b32 v7, 8, v7
    v_lshrrev_b32 v9, 1, v6
    v_lshl_add_u32 v7, v9, 4, v7
    v_and_b32 v9, 1, v6
    v_lshl_add_u32 v7, v9, 3, v7
    v_add_u32 v7, 16384, v7
    v_xor_b32 v9, 0, v8
    v_lshl_add_u32 v176, v9, 5, v7
    v_xor_b32 v9, 1, v8
    v_lshl_add_u32 v177, v9, 5, v7
    v_xor_b32 v9, 2, v8
    v_lshl_add_u32 v178, v9, 5, v7
    v_xor_b32 v9, 3, v8
    v_lshl_add_u32 v179, v9, 5, v7
    v_xor_b32 v9, 4, v8
    v_lshl_add_u32 v180, v9, 5, v7
    v_xor_b32 v9, 5, v8
    v_lshl_add_u32 v181, v9, 5, v7
    v_xor_b32 v9, 6, v8
    v_lshl_add_u32 v182, v9, 5, v7
    v_xor_b32 v9, 7, v8
    v_lshl_add_u32 v183, v9, 5, v7
    v_mov_b32 v216, 0
    v_mov_b32 v217, 0
    v_mov_b32 v218, 0
    v_mov_b32 v219, 0
    v_mov_b32 v220, 0
    v_mov_b32 v221, 0
    v_mov_b32 v222, 0
    v_mov_b32 v223, 0
    v_mov_b32 v224, 0
    v_mov_b32 v225, 0
    v_mov_b32 v226, 0
    v_mov_b32 v227, 0
    v_mov_b32 v228, 0
    v_mov_b32 v229, 0
    v_mov_b32 v230, 0
    v_mov_b32 v231, 0
    v_mov_b32 v248, 0
    v_mov_b32 v249, 0
    v_mov_b32 v250, 0
    v_mov_b32 v251, 0
    v_mov_b32 v252, 0
    v_mov_b32 v253, 0
    v_mov_b32 v254, 0
    v_mov_b32 v255, 0
    v_mov_b32 v150, 1.0
    s_waitcnt vmcnt(9)
    s_barrier
    ds_bpermute_b32 v16, v13, v64
    ds_bpermute_b32 v17, v13, v65
    ds_bpermute_b32 v18, v13, v66
    ds_bpermute_b32 v19, v13, v67
    ds_bpermute_b32 v20, v13, v68
    ds_bpermute_b32 v21, v13, v69
    ds_bpermute_b32 v22, v13, v70
    ds_bpermute_b32 v23, v13, v71
    ds_bpermute_b32 v24, v13, v72
    ds_bpermute_b32 v25, v13, v73
    ds_bpermute_b32 v26, v13, v74
    ds_bpermute_b32 v27, v13, v75
    ds_read_b64_tr_b16 a[96:97], v56 offset:0
    ds_read_b64_tr_b16 a[98:99], v56 offset:1024
    ds_read_b64_tr_b16 a[100:101], v56 offset:8
    ds_read_b64_tr_b16 a[102:103], v56 offset:1032
    ds_read_b64_tr_b16 a[104:105], v57 offset:0
    ds_read_b64_tr_b16 a[106:107], v57 offset:1024
    ds_read_b64_tr_b16 a[108:109], v57 offset:8
    ds_read_b64_tr_b16 a[110:111], v57 offset:1032
    ds_read_b64_tr_b16 a[112:113], v58 offset:0
    ds_read_b64_tr_b16 a[114:115], v58 offset:1024
    ds_read_b64_tr_b16 a[116:117], v58 offset:8
    ds_read_b64_tr_b16 a[118:119], v58 offset:1032
    ds_read_b64_tr_b16 a[120:121], v59 offset:0
    ds_read_b64_tr_b16 a[122:123], v59 offset:1024
    ds_read_b64_tr_b16 a[124:125], v59 offset:8
    ds_read_b64_tr_b16 a[126:127], v59 offset:1032
    s_waitcnt lgkmcnt(0) vmcnt(6)
    s_barrier
    v_mfma_f32_16x16x32_bf16 a[0:3], a[96:99], v[16:19], a[0:3]
    ds_bpermute_b32 v28, v13, v76
    v_mfma_f32_16x16x32_bf16 a[32:35], a[96:99], v[20:23], a[32:35]
    ds_bpermute_b32 v29, v13, v77
    ds_bpermute_b32 v30, v13, v78
    v_mfma_f32_16x16x32_bf16 a[64:67], a[96:99], v[24:27], a[64:67]
    ds_bpermute_b32 v31, v13, v79
    v_mfma_f32_16x16x32_bf16 a[4:7], a[100:103], v[16:19], a[4:7]
    ds_bpermute_b32 v32, v13, v80
    ds_bpermute_b32 v33, v13, v81
    v_mfma_f32_16x16x32_bf16 a[36:39], a[100:103], v[20:23], a[36:39]
    ds_bpermute_b32 v34, v13, v82
    v_mfma_f32_16x16x32_bf16 a[68:71], a[100:103], v[24:27], a[68:71]
    ds_bpermute_b32 v35, v13, v83
    v_mfma_f32_16x16x32_bf16 a[8:11], a[104:107], v[16:19], a[8:11]
    ds_bpermute_b32 v36, v13, v84
    ds_bpermute_b32 v37, v13, v85
    v_mfma_f32_16x16x32_bf16 a[40:43], a[104:107], v[20:23], a[40:43]
    ds_bpermute_b32 v38, v13, v86
    v_mfma_f32_16x16x32_bf16 a[72:75], a[104:107], v[24:27], a[72:75]
    ds_bpermute_b32 v39, v13, v87
    ds_read_b64_tr_b16 a[128:129], v56 offset:8192
    v_mfma_f32_16x16x32_bf16 a[12:15], a[108:111], v[16:19], a[12:15]
    ds_read_b64_tr_b16 a[130:131], v56 offset:9216
    v_mfma_f32_16x16x32_bf16 a[44:47], a[108:111], v[20:23], a[44:47]
    ds_read_b64_tr_b16 a[132:133], v56 offset:8200
    v_mfma_f32_16x16x32_bf16 a[76:79], a[108:111], v[24:27], a[76:79]
    ds_read_b64_tr_b16 a[134:135], v56 offset:9224
    ds_read_b64_tr_b16 a[136:137], v57 offset:8192
    v_mfma_f32_16x16x32_bf16 a[16:19], a[112:115], v[16:19], a[16:19]
    ds_read_b64_tr_b16 a[138:139], v57 offset:9216
    v_mfma_f32_16x16x32_bf16 a[48:51], a[112:115], v[20:23], a[48:51]
    ds_read_b64_tr_b16 a[140:141], v57 offset:8200
    ds_read_b64_tr_b16 a[142:143], v57 offset:9224
    v_mfma_f32_16x16x32_bf16 a[80:83], a[112:115], v[24:27], a[80:83]
    ds_read_b64_tr_b16 a[144:145], v58 offset:8192
    v_mfma_f32_16x16x32_bf16 a[20:23], a[116:119], v[16:19], a[20:23]
    ds_read_b64_tr_b16 a[146:147], v58 offset:9216
    v_mfma_f32_16x16x32_bf16 a[52:55], a[116:119], v[20:23], a[52:55]
    ds_read_b64_tr_b16 a[148:149], v58 offset:8200
    ds_read_b64_tr_b16 a[150:151], v58 offset:9224
    s_add_u32 s47, s46, 4
    s_and_b32 s47, s47, 15
    v_mfma_f32_16x16x32_bf16 a[84:87], a[116:119], v[24:27], a[84:87]
    ds_read_b64_tr_b16 a[152:153], v59 offset:8192
    s_lshl_b32 s47, s47, 6
    v_mfma_f32_16x16x32_bf16 a[24:27], a[120:123], v[16:19], a[24:27]
    ds_read_b64_tr_b16 a[154:155], v59 offset:9216
    ds_read_b64_tr_b16 a[156:157], v59 offset:8200
    buffer_load_dwordx4 v[112:115], v10, s[20:23], s47 offen
    v_mfma_f32_16x16x32_bf16 a[56:59], a[120:123], v[20:23], a[56:59]
    ds_read_b64_tr_b16 a[158:159], v59 offset:9224
    v_mfma_f32_16x16x32_bf16 a[88:91], a[120:123], v[24:27], a[88:91]
    buffer_load_dwordx4 v[116:119], v11, s[20:23], s47 offen
    v_mfma_f32_16x16x32_bf16 a[28:31], a[124:127], v[16:19], a[28:31]
    v_mfma_f32_16x16x32_bf16 a[60:63], a[124:127], v[20:23], a[60:63]
    buffer_load_dwordx4 v[120:123], v12, s[20:23], s47 offen
    v_mfma_f32_16x16x32_bf16 a[92:95], a[124:127], v[24:27], a[92:95]
    s_waitcnt lgkmcnt(0) vmcnt(6)
    s_barrier
    v_mfma_f32_16x16x32_bf16 a[0:3], a[128:131], v[28:31], a[0:3]
    ds_bpermute_b32 v16, v13, v88
    v_mfma_f32_16x16x32_bf16 a[32:35], a[128:131], v[32:35], a[32:35]
    ds_bpermute_b32 v17, v13, v89
    ds_bpermute_b32 v18, v13, v90
    v_mfma_f32_16x16x32_bf16 a[64:67], a[128:131], v[36:39], a[64:67]
    ds_bpermute_b32 v19, v13, v91
    v_mfma_f32_16x16x32_bf16 a[4:7], a[132:135], v[28:31], a[4:7]
    ds_bpermute_b32 v20, v13, v92
    ds_bpermute_b32 v21, v13, v93
    v_mfma_f32_16x16x32_bf16 a[36:39], a[132:135], v[32:35], a[36:39]
    ds_bpermute_b32 v22, v13, v94
    v_mfma_f32_16x16x32_bf16 a[68:71], a[132:135], v[36:39], a[68:71]
    ds_bpermute_b32 v23, v13, v95
    v_mfma_f32_16x16x32_bf16 a[8:11], a[136:139], v[28:31], a[8:11]
    ds_bpermute_b32 v24, v13, v96
    ds_bpermute_b32 v25, v13, v97
    v_mfma_f32_16x16x32_bf16 a[40:43], a[136:139], v[32:35], a[40:43]
    ds_bpermute_b32 v26, v13, v98
    v_mfma_f32_16x16x32_bf16 a[72:75], a[136:139], v[36:39], a[72:75]
    ds_bpermute_b32 v27, v13, v99
    ds_read_b64_tr_b16 a[96:97], v56 offset:16384
    v_mfma_f32_16x16x32_bf16 a[12:15], a[140:143], v[28:31], a[12:15]
    ds_read_b64_tr_b16 a[98:99], v56 offset:17408
    v_mfma_f32_16x16x32_bf16 a[44:47], a[140:143], v[32:35], a[44:47]
    ds_read_b64_tr_b16 a[100:101], v56 offset:16392
    v_mfma_f32_16x16x32_bf16 a[76:79], a[140:143], v[36:39], a[76:79]
    ds_read_b64_tr_b16 a[102:103], v56 offset:17416
    ds_read_b64_tr_b16 a[104:105], v57 offset:16384
    v_mfma_f32_16x16x32_bf16 a[16:19], a[144:147], v[28:31], a[16:19]
    ds_read_b64_tr_b16 a[106:107], v57 offset:17408
    v_mfma_f32_16x16x32_bf16 a[48:51], a[144:147], v[32:35], a[48:51]
    ds_read_b64_tr_b16 a[108:109], v57 offset:16392
    ds_read_b64_tr_b16 a[110:111], v57 offset:17416
    v_mfma_f32_16x16x32_bf16 a[80:83], a[144:147], v[36:39], a[80:83]
    ds_read_b64_tr_b16 a[112:113], v58 offset:16384
    v_mfma_f32_16x16x32_bf16 a[20:23], a[148:151], v[28:31], a[20:23]
    ds_read_b64_tr_b16 a[114:115], v58 offset:17408
    v_mfma_f32_16x16x32_bf16 a[52:55], a[148:151], v[32:35], a[52:55]
    ds_read_b64_tr_b16 a[116:117], v58 offset:16392
    ds_read_b64_tr_b16 a[118:119], v58 offset:17416
    s_add_u32 s47, s46, 5
    s_and_b32 s47, s47, 15
    v_mfma_f32_16x16x32_bf16 a[84:87], a[148:151], v[36:39], a[84:87]
    ds_read_b64_tr_b16 a[120:121], v59 offset:16384
    s_lshl_b32 s47, s47, 6
    v_mfma_f32_16x16x32_bf16 a[24:27], a[152:155], v[28:31], a[24:27]
    ds_read_b64_tr_b16 a[122:123], v59 offset:17408
    ds_read_b64_tr_b16 a[124:125], v59 offset:16392
    buffer_load_dwordx4 v[124:127], v10, s[20:23], s47 offen
    v_mfma_f32_16x16x32_bf16 a[56:59], a[152:155], v[32:35], a[56:59]
    ds_read_b64_tr_b16 a[126:127], v59 offset:17416
    v_mfma_f32_16x16x32_bf16 a[88:91], a[152:155], v[36:39], a[88:91]
    buffer_load_dwordx4 v[128:131], v11, s[20:23], s47 offen
    v_mfma_f32_16x16x32_bf16 a[28:31], a[156:159], v[28:31], a[28:31]
    v_mfma_f32_16x16x32_bf16 a[60:63], a[156:159], v[32:35], a[60:63]
    buffer_load_dwordx4 v[132:135], v12, s[20:23], s47 offen
    v_mfma_f32_16x16x32_bf16 a[92:95], a[156:159], v[36:39], a[92:95]
    s_waitcnt lgkmcnt(0) vmcnt(6)
    s_barrier
    v_mfma_f32_16x16x32_bf16 a[0:3], a[96:99], v[16:19], a[0:3]
    ds_bpermute_b32 v28, v13, v100
    v_mfma_f32_16x16x32_bf16 a[32:35], a[96:99], v[20:23], a[32:35]
    ds_bpermute_b32 v29, v13, v101
    ds_bpermute_b32 v30, v13, v102
    v_mfma_f32_16x16x32_bf16 a[64:67], a[96:99], v[24:27], a[64:67]
    ds_bpermute_b32 v31, v13, v103
    v_mfma_f32_16x16x32_bf16 a[4:7], a[100:103], v[16:19], a[4:7]
    ds_bpermute_b32 v32, v13, v104
    ds_bpermute_b32 v33, v13, v105
    v_mfma_f32_16x16x32_bf16 a[36:39], a[100:103], v[20:23], a[36:39]
    ds_bpermute_b32 v34, v13, v106
    v_mfma_f32_16x16x32_bf16 a[68:71], a[100:103], v[24:27], a[68:71]
    ds_bpermute_b32 v35, v13, v107
    v_mfma_f32_16x16x32_bf16 a[8:11], a[104:107], v[16:19], a[8:11]
    ds_bpermute_b32 v36, v13, v108
    ds_bpermute_b32 v37, v13, v109
    v_mfma_f32_16x16x32_bf16 a[40:43], a[104:107], v[20:23], a[40:43]
    ds_bpermute_b32 v38, v13, v110
    v_mfma_f32_16x16x32_bf16 a[72:75], a[104:107], v[24:27], a[72:75]
    ds_bpermute_b32 v39, v13, v111
    ds_read_b64_tr_b16 a[128:129], v56 offset:24576
    v_mfma_f32_16x16x32_bf16 a[12:15], a[108:111], v[16:19], a[12:15]
    ds_read_b64_tr_b16 a[130:131], v56 offset:25600
    v_mfma_f32_16x16x32_bf16 a[44:47], a[108:111], v[20:23], a[44:47]
    ds_read_b64_tr_b16 a[132:133], v56 offset:24584
    v_mfma_f32_16x16x32_bf16 a[76:79], a[108:111], v[24:27], a[76:79]
    ds_read_b64_tr_b16 a[134:135], v56 offset:25608
    ds_read_b64_tr_b16 a[136:137], v57 offset:24576
    v_mfma_f32_16x16x32_bf16 a[16:19], a[112:115], v[16:19], a[16:19]
    ds_read_b64_tr_b16 a[138:139], v57 offset:25600
    v_mfma_f32_16x16x32_bf16 a[48:51], a[112:115], v[20:23], a[48:51]
    ds_read_b64_tr_b16 a[140:141], v57 offset:24584
    ds_read_b64_tr_b16 a[142:143], v57 offset:25608
    v_mfma_f32_16x16x32_bf16 a[80:83], a[112:115], v[24:27], a[80:83]
    ds_read_b64_tr_b16 a[144:145], v58 offset:24576
    v_mfma_f32_16x16x32_bf16 a[20:23], a[116:119], v[16:19], a[20:23]
    ds_read_b64_tr_b16 a[146:147], v58 offset:25600
    v_mfma_f32_16x16x32_bf16 a[52:55], a[116:119], v[20:23], a[52:55]
    ds_read_b64_tr_b16 a[148:149], v58 offset:24584
    ds_read_b64_tr_b16 a[150:151], v58 offset:25608
    s_add_u32 s47, s46, 6
    s_and_b32 s47, s47, 15
    v_mfma_f32_16x16x32_bf16 a[84:87], a[116:119], v[24:27], a[84:87]
    ds_read_b64_tr_b16 a[152:153], v59 offset:24576
    s_lshl_b32 s47, s47, 6
    v_mfma_f32_16x16x32_bf16 a[24:27], a[120:123], v[16:19], a[24:27]
    ds_read_b64_tr_b16 a[154:155], v59 offset:25600
    ds_read_b64_tr_b16 a[156:157], v59 offset:24584
    buffer_load_dwordx4 v[64:67], v10, s[20:23], s47 offen
    v_mfma_f32_16x16x32_bf16 a[56:59], a[120:123], v[20:23], a[56:59]
    ds_read_b64_tr_b16 a[158:159], v59 offset:25608
    v_mfma_f32_16x16x32_bf16 a[88:91], a[120:123], v[24:27], a[88:91]
    buffer_load_dwordx4 v[68:71], v11, s[20:23], s47 offen
    v_mfma_f32_16x16x32_bf16 a[28:31], a[124:127], v[16:19], a[28:31]
    v_mfma_f32_16x16x32_bf16 a[60:63], a[124:127], v[20:23], a[60:63]
    buffer_load_dwordx4 v[72:75], v12, s[20:23], s47 offen
    v_mfma_f32_16x16x32_bf16 a[92:95], a[124:127], v[24:27], a[92:95]
    s_waitcnt lgkmcnt(0) vmcnt(6)
    s_barrier
    v_mfma_f32_16x16x32_bf16 a[0:3], a[128:131], v[28:31], a[0:3]
    ds_bpermute_b32 v16, v13, v112
    v_mfma_f32_16x16x32_bf16 a[32:35], a[128:131], v[32:35], a[32:35]
    ds_bpermute_b32 v17, v13, v113
    ds_bpermute_b32 v18, v13, v114
    v_mfma_f32_16x16x32_bf16 a[64:67], a[128:131], v[36:39], a[64:67]
    ds_bpermute_b32 v19, v13, v115
    v_mfma_f32_16x16x32_bf16 a[4:7], a[132:135], v[28:31], a[4:7]
    ds_bpermute_b32 v20, v13, v116
    ds_bpermute_b32 v21, v13, v117
    v_mfma_f32_16x16x32_bf16 a[36:39], a[132:135], v[32:35], a[36:39]
    ds_bpermute_b32 v22, v13, v118
    v_mfma_f32_16x16x32_bf16 a[68:71], a[132:135], v[36:39], a[68:71]
    ds_bpermute_b32 v23, v13, v119
    v_mfma_f32_16x16x32_bf16 a[8:11], a[136:139], v[28:31], a[8:11]
    ds_bpermute_b32 v24, v13, v120
    ds_bpermute_b32 v25, v13, v121
    v_mfma_f32_16x16x32_bf16 a[40:43], a[136:139], v[32:35], a[40:43]
    ds_bpermute_b32 v26, v13, v122
    v_mfma_f32_16x16x32_bf16 a[72:75], a[136:139], v[36:39], a[72:75]
    ds_bpermute_b32 v27, v13, v123
    ds_read_b64_tr_b16 a[96:97], v56 offset:32768
    v_mfma_f32_16x16x32_bf16 a[12:15], a[140:143], v[28:31], a[12:15]
    ds_read_b64_tr_b16 a[98:99], v56 offset:33792
    v_mfma_f32_16x16x32_bf16 a[44:47], a[140:143], v[32:35], a[44:47]
    ds_read_b64_tr_b16 a[100:101], v56 offset:32776
    v_mfma_f32_16x16x32_bf16 a[76:79], a[140:143], v[36:39], a[76:79]
    ds_read_b64_tr_b16 a[102:103], v56 offset:33800
    ds_read_b64_tr_b16 a[104:105], v57 offset:32768
    v_mfma_f32_16x16x32_bf16 a[16:19], a[144:147], v[28:31], a[16:19]
    ds_read_b64_tr_b16 a[106:107], v57 offset:33792
    v_mfma_f32_16x16x32_bf16 a[48:51], a[144:147], v[32:35], a[48:51]
    ds_read_b64_tr_b16 a[108:109], v57 offset:32776
    ds_read_b64_tr_b16 a[110:111], v57 offset:33800
    v_mfma_f32_16x16x32_bf16 a[80:83], a[144:147], v[36:39], a[80:83]
    ds_read_b64_tr_b16 a[112:113], v58 offset:32768
    v_mfma_f32_16x16x32_bf16 a[20:23], a[148:151], v[28:31], a[20:23]
    ds_read_b64_tr_b16 a[114:115], v58 offset:33792
    v_mfma_f32_16x16x32_bf16 a[52:55], a[148:151], v[32:35], a[52:55]
    ds_read_b64_tr_b16 a[116:117], v58 offset:32776
    ds_read_b64_tr_b16 a[118:119], v58 offset:33800
    s_add_u32 s47, s46, 7
    s_and_b32 s47, s47, 15
    v_mfma_f32_16x16x32_bf16 a[84:87], a[148:151], v[36:39], a[84:87]
    ds_read_b64_tr_b16 a[120:121], v59 offset:32768
    s_lshl_b32 s47, s47, 6
    v_mfma_f32_16x16x32_bf16 a[24:27], a[152:155], v[28:31], a[24:27]
    ds_read_b64_tr_b16 a[122:123], v59 offset:33792
    ds_read_b64_tr_b16 a[124:125], v59 offset:32776
    buffer_load_dwordx4 v[76:79], v10, s[20:23], s47 offen
    v_mfma_f32_16x16x32_bf16 a[56:59], a[152:155], v[32:35], a[56:59]
    ds_read_b64_tr_b16 a[126:127], v59 offset:33800
    v_mfma_f32_16x16x32_bf16 a[88:91], a[152:155], v[36:39], a[88:91]
    buffer_load_dwordx4 v[80:83], v11, s[20:23], s47 offen
    v_mfma_f32_16x16x32_bf16 a[28:31], a[156:159], v[28:31], a[28:31]
    v_mfma_f32_16x16x32_bf16 a[60:63], a[156:159], v[32:35], a[60:63]
    buffer_load_dwordx4 v[84:87], v12, s[20:23], s47 offen
    v_mfma_f32_16x16x32_bf16 a[92:95], a[156:159], v[36:39], a[92:95]
    s_waitcnt lgkmcnt(0) vmcnt(6)
    s_barrier
    v_mfma_f32_16x16x32_bf16 a[0:3], a[96:99], v[16:19], a[0:3]
    ds_bpermute_b32 v28, v13, v124
    v_mfma_f32_16x16x32_bf16 a[32:35], a[96:99], v[20:23], a[32:35]
    ds_bpermute_b32 v29, v13, v125
    ds_bpermute_b32 v30, v13, v126
    v_mfma_f32_16x16x32_bf16 a[64:67], a[96:99], v[24:27], a[64:67]
    ds_bpermute_b32 v31, v13, v127
    v_mfma_f32_16x16x32_bf16 a[4:7], a[100:103], v[16:19], a[4:7]
    ds_bpermute_b32 v32, v13, v128
    ds_bpermute_b32 v33, v13, v129
    v_mfma_f32_16x16x32_bf16 a[36:39], a[100:103], v[20:23], a[36:39]
    ds_bpermute_b32 v34, v13, v130
    v_mfma_f32_16x16x32_bf16 a[68:71], a[100:103], v[24:27], a[68:71]
    ds_bpermute_b32 v35, v13, v131
    v_mfma_f32_16x16x32_bf16 a[8:11], a[104:107], v[16:19], a[8:11]
    ds_bpermute_b32 v36, v13, v132
    ds_bpermute_b32 v37, v13, v133
    v_mfma_f32_16x16x32_bf16 a[40:43], a[104:107], v[20:23], a[40:43]
    ds_bpermute_b32 v38, v13, v134
    v_mfma_f32_16x16x32_bf16 a[72:75], a[104:107], v[24:27], a[72:75]
    ds_bpermute_b32 v39, v13, v135
    ds_read_b64_tr_b16 a[128:129], v56 offset:40960
    v_mfma_f32_16x16x32_bf16 a[12:15], a[108:111], v[16:19], a[12:15]
    ds_read_b64_tr_b16 a[130:131], v56 offset:41984
    v_mfma_f32_16x16x32_bf16 a[44:47], a[108:111], v[20:23], a[44:47]
    ds_read_b64_tr_b16 a[132:133], v56 offset:40968
    v_mfma_f32_16x16x32_bf16 a[76:79], a[108:111], v[24:27], a[76:79]
    ds_read_b64_tr_b16 a[134:135], v56 offset:41992
    ds_read_b64_tr_b16 a[136:137], v57 offset:40960
    v_mfma_f32_16x16x32_bf16 a[16:19], a[112:115], v[16:19], a[16:19]
    ds_read_b64_tr_b16 a[138:139], v57 offset:41984
    v_mfma_f32_16x16x32_bf16 a[48:51], a[112:115], v[20:23], a[48:51]
    ds_read_b64_tr_b16 a[140:141], v57 offset:40968
    ds_read_b64_tr_b16 a[142:143], v57 offset:41992
    v_mfma_f32_16x16x32_bf16 a[80:83], a[112:115], v[24:27], a[80:83]
    ds_read_b64_tr_b16 a[144:145], v58 offset:40960
    v_mfma_f32_16x16x32_bf16 a[20:23], a[116:119], v[16:19], a[20:23]
    ds_read_b64_tr_b16 a[146:147], v58 offset:41984
    v_mfma_f32_16x16x32_bf16 a[52:55], a[116:119], v[20:23], a[52:55]
    ds_read_b64_tr_b16 a[148:149], v58 offset:40968
    ds_read_b64_tr_b16 a[150:151], v58 offset:41992
    s_add_u32 s47, s46, 8
    s_and_b32 s47, s47, 15
    v_mfma_f32_16x16x32_bf16 a[84:87], a[116:119], v[24:27], a[84:87]
    ds_read_b64_tr_b16 a[152:153], v59 offset:40960
    s_lshl_b32 s47, s47, 6
    v_mfma_f32_16x16x32_bf16 a[24:27], a[120:123], v[16:19], a[24:27]
    ds_read_b64_tr_b16 a[154:155], v59 offset:41984
    ds_read_b64_tr_b16 a[156:157], v59 offset:40968
    buffer_load_dwordx4 v[88:91], v10, s[20:23], s47 offen
    v_mfma_f32_16x16x32_bf16 a[56:59], a[120:123], v[20:23], a[56:59]
    ds_read_b64_tr_b16 a[158:159], v59 offset:41992
    v_mfma_f32_16x16x32_bf16 a[88:91], a[120:123], v[24:27], a[88:91]
    buffer_load_dwordx4 v[92:95], v11, s[20:23], s47 offen
    v_mfma_f32_16x16x32_bf16 a[28:31], a[124:127], v[16:19], a[28:31]
    v_mfma_f32_16x16x32_bf16 a[60:63], a[124:127], v[20:23], a[60:63]
    buffer_load_dwordx4 v[96:99], v12, s[20:23], s47 offen
    v_mfma_f32_16x16x32_bf16 a[92:95], a[124:127], v[24:27], a[92:95]
    s_waitcnt lgkmcnt(0) vmcnt(6)
    s_barrier
    v_mfma_f32_16x16x32_bf16 a[0:3], a[128:131], v[28:31], a[0:3]
    ds_bpermute_b32 v16, v13, v64
    v_mfma_f32_16x16x32_bf16 a[32:35], a[128:131], v[32:35], a[32:35]
    ds_bpermute_b32 v17, v13, v65
    ds_bpermute_b32 v18, v13, v66
    v_mfma_f32_16x16x32_bf16 a[64:67], a[128:131], v[36:39], a[64:67]
    ds_bpermute_b32 v19, v13, v67
    v_mfma_f32_16x16x32_bf16 a[4:7], a[132:135], v[28:31], a[4:7]
    ds_bpermute_b32 v20, v13, v68
    ds_bpermute_b32 v21, v13, v69
    v_mfma_f32_16x16x32_bf16 a[36:39], a[132:135], v[32:35], a[36:39]
    ds_bpermute_b32 v22, v13, v70
    v_mfma_f32_16x16x32_bf16 a[68:71], a[132:135], v[36:39], a[68:71]
    ds_bpermute_b32 v23, v13, v71
    v_mfma_f32_16x16x32_bf16 a[8:11], a[136:139], v[28:31], a[8:11]
    ds_bpermute_b32 v24, v13, v72
    ds_bpermute_b32 v25, v13, v73
    v_mfma_f32_16x16x32_bf16 a[40:43], a[136:139], v[32:35], a[40:43]
    ds_bpermute_b32 v26, v13, v74
    v_mfma_f32_16x16x32_bf16 a[72:75], a[136:139], v[36:39], a[72:75]
    ds_bpermute_b32 v27, v13, v75
    ds_read_b64_tr_b16 a[96:97], v56 offset:49152
    v_mfma_f32_16x16x32_bf16 a[12:15], a[140:143], v[28:31], a[12:15]
    ds_read_b64_tr_b16 a[98:99], v56 offset:50176
    v_mfma_f32_16x16x32_bf16 a[44:47], a[140:143], v[32:35], a[44:47]
    ds_read_b64_tr_b16 a[100:101], v56 offset:49160
    v_mfma_f32_16x16x32_bf16 a[76:79], a[140:143], v[36:39], a[76:79]
    ds_read_b64_tr_b16 a[102:103], v56 offset:50184
    ds_read_b64_tr_b16 a[104:105], v57 offset:49152
    v_mfma_f32_16x16x32_bf16 a[16:19], a[144:147], v[28:31], a[16:19]
    ds_read_b64_tr_b16 a[106:107], v57 offset:50176
    v_mfma_f32_16x16x32_bf16 a[48:51], a[144:147], v[32:35], a[48:51]
    ds_read_b64_tr_b16 a[108:109], v57 offset:49160
    ds_read_b64_tr_b16 a[110:111], v57 offset:50184
    v_mfma_f32_16x16x32_bf16 a[80:83], a[144:147], v[36:39], a[80:83]
    ds_read_b64_tr_b16 a[112:113], v58 offset:49152
    v_mfma_f32_16x16x32_bf16 a[20:23], a[148:151], v[28:31], a[20:23]
    ds_read_b64_tr_b16 a[114:115], v58 offset:50176
    v_mfma_f32_16x16x32_bf16 a[52:55], a[148:151], v[32:35], a[52:55]
    ds_read_b64_tr_b16 a[116:117], v58 offset:49160
    ds_read_b64_tr_b16 a[118:119], v58 offset:50184
    s_add_u32 s47, s46, 9
    s_and_b32 s47, s47, 15
    v_mfma_f32_16x16x32_bf16 a[84:87], a[148:151], v[36:39], a[84:87]
    ds_read_b64_tr_b16 a[120:121], v59 offset:49152
    s_lshl_b32 s47, s47, 6
    v_mfma_f32_16x16x32_bf16 a[24:27], a[152:155], v[28:31], a[24:27]
    ds_read_b64_tr_b16 a[122:123], v59 offset:50176
    ds_read_b64_tr_b16 a[124:125], v59 offset:49160
    buffer_load_dwordx4 v[100:103], v10, s[20:23], s47 offen
    v_mfma_f32_16x16x32_bf16 a[56:59], a[152:155], v[32:35], a[56:59]
    ds_read_b64_tr_b16 a[126:127], v59 offset:50184
    v_mfma_f32_16x16x32_bf16 a[88:91], a[152:155], v[36:39], a[88:91]
    buffer_load_dwordx4 v[104:107], v11, s[20:23], s47 offen
    v_mfma_f32_16x16x32_bf16 a[28:31], a[156:159], v[28:31], a[28:31]
    v_mfma_f32_16x16x32_bf16 a[60:63], a[156:159], v[32:35], a[60:63]
    buffer_load_dwordx4 v[108:111], v12, s[20:23], s47 offen
    v_mfma_f32_16x16x32_bf16 a[92:95], a[156:159], v[36:39], a[92:95]
    s_waitcnt lgkmcnt(0) vmcnt(6)
    s_barrier
    v_mfma_f32_16x16x32_bf16 a[0:3], a[96:99], v[16:19], a[0:3]
    ds_bpermute_b32 v28, v13, v76
    v_mfma_f32_16x16x32_bf16 a[32:35], a[96:99], v[20:23], a[32:35]
    ds_bpermute_b32 v29, v13, v77
    ds_bpermute_b32 v30, v13, v78
    v_mfma_f32_16x16x32_bf16 a[64:67], a[96:99], v[24:27], a[64:67]
    ds_bpermute_b32 v31, v13, v79
    v_mfma_f32_16x16x32_bf16 a[4:7], a[100:103], v[16:19], a[4:7]
    ds_bpermute_b32 v32, v13, v80
    ds_bpermute_b32 v33, v13, v81
    v_mfma_f32_16x16x32_bf16 a[36:39], a[100:103], v[20:23], a[36:39]
    ds_bpermute_b32 v34, v13, v82
    v_mfma_f32_16x16x32_bf16 a[68:71], a[100:103], v[24:27], a[68:71]
    ds_bpermute_b32 v35, v13, v83
    v_mfma_f32_16x16x32_bf16 a[8:11], a[104:107], v[16:19], a[8:11]
    ds_bpermute_b32 v36, v13, v84
    ds_bpermute_b32 v37, v13, v85
    v_mfma_f32_16x16x32_bf16 a[40:43], a[104:107], v[20:23], a[40:43]
    ds_bpermute_b32 v38, v13, v86
    v_mfma_f32_16x16x32_bf16 a[72:75], a[104:107], v[24:27], a[72:75]
    ds_bpermute_b32 v39, v13, v87
    ds_read_b64_tr_b16 a[128:129], v56 offset:57344
    v_mfma_f32_16x16x32_bf16 a[12:15], a[108:111], v[16:19], a[12:15]
    ds_read_b64_tr_b16 a[130:131], v56 offset:58368
    v_mfma_f32_16x16x32_bf16 a[44:47], a[108:111], v[20:23], a[44:47]
    ds_read_b64_tr_b16 a[132:133], v56 offset:57352
    v_mfma_f32_16x16x32_bf16 a[76:79], a[108:111], v[24:27], a[76:79]
    ds_read_b64_tr_b16 a[134:135], v56 offset:58376
    ds_read_b64_tr_b16 a[136:137], v57 offset:57344
    v_mfma_f32_16x16x32_bf16 a[16:19], a[112:115], v[16:19], a[16:19]
    ds_read_b64_tr_b16 a[138:139], v57 offset:58368
    v_mfma_f32_16x16x32_bf16 a[48:51], a[112:115], v[20:23], a[48:51]
    ds_read_b64_tr_b16 a[140:141], v57 offset:57352
    ds_read_b64_tr_b16 a[142:143], v57 offset:58376
    v_mfma_f32_16x16x32_bf16 a[80:83], a[112:115], v[24:27], a[80:83]
    ds_read_b64_tr_b16 a[144:145], v58 offset:57344
    v_mfma_f32_16x16x32_bf16 a[20:23], a[116:119], v[16:19], a[20:23]
    ds_read_b64_tr_b16 a[146:147], v58 offset:58368
    v_mfma_f32_16x16x32_bf16 a[52:55], a[116:119], v[20:23], a[52:55]
    ds_read_b64_tr_b16 a[148:149], v58 offset:57352
    ds_read_b64_tr_b16 a[150:151], v58 offset:58376
    s_add_u32 s47, s46, 10
    s_and_b32 s47, s47, 15
    v_mfma_f32_16x16x32_bf16 a[84:87], a[116:119], v[24:27], a[84:87]
    ds_read_b64_tr_b16 a[152:153], v59 offset:57344
    s_lshl_b32 s47, s47, 6
    v_mfma_f32_16x16x32_bf16 a[24:27], a[120:123], v[16:19], a[24:27]
    ds_read_b64_tr_b16 a[154:155], v59 offset:58368
    ds_read_b64_tr_b16 a[156:157], v59 offset:57352
    buffer_load_dwordx4 v[112:115], v10, s[20:23], s47 offen
    v_mfma_f32_16x16x32_bf16 a[56:59], a[120:123], v[20:23], a[56:59]
    ds_read_b64_tr_b16 a[158:159], v59 offset:58376
    v_mfma_f32_16x16x32_bf16 a[88:91], a[120:123], v[24:27], a[88:91]
    buffer_load_dwordx4 v[116:119], v11, s[20:23], s47 offen
    v_mfma_f32_16x16x32_bf16 a[28:31], a[124:127], v[16:19], a[28:31]
    v_mfma_f32_16x16x32_bf16 a[60:63], a[124:127], v[20:23], a[60:63]
    buffer_load_dwordx4 v[120:123], v12, s[20:23], s47 offen
    v_mfma_f32_16x16x32_bf16 a[92:95], a[124:127], v[24:27], a[92:95]
    s_waitcnt lgkmcnt(0) vmcnt(6)
    s_barrier
    v_mfma_f32_16x16x32_bf16 a[0:3], a[128:131], v[28:31], a[0:3]
    ds_bpermute_b32 v16, v13, v88
    v_mfma_f32_16x16x32_bf16 a[32:35], a[128:131], v[32:35], a[32:35]
    ds_bpermute_b32 v17, v13, v89
    ds_bpermute_b32 v18, v13, v90
    v_mfma_f32_16x16x32_bf16 a[64:67], a[128:131], v[36:39], a[64:67]
    ds_bpermute_b32 v19, v13, v91
    v_mfma_f32_16x16x32_bf16 a[4:7], a[132:135], v[28:31], a[4:7]
    ds_bpermute_b32 v20, v13, v92
    ds_bpermute_b32 v21, v13, v93
    v_mfma_f32_16x16x32_bf16 a[36:39], a[132:135], v[32:35], a[36:39]
    ds_bpermute_b32 v22, v13, v94
    v_mfma_f32_16x16x32_bf16 a[68:71], a[132:135], v[36:39], a[68:71]
    ds_bpermute_b32 v23, v13, v95
    v_mfma_f32_16x16x32_bf16 a[8:11], a[136:139], v[28:31], a[8:11]
    ds_bpermute_b32 v24, v13, v96
    ds_bpermute_b32 v25, v13, v97
    v_mfma_f32_16x16x32_bf16 a[40:43], a[136:139], v[32:35], a[40:43]
    ds_bpermute_b32 v26, v13, v98
    v_mfma_f32_16x16x32_bf16 a[72:75], a[136:139], v[36:39], a[72:75]
    ds_bpermute_b32 v27, v13, v99
    ds_read_b64_tr_b16 a[96:97], v56 offset:0
    v_mfma_f32_16x16x32_bf16 a[12:15], a[140:143], v[28:31], a[12:15]
    ds_read_b64_tr_b16 a[98:99], v56 offset:1024
    v_mfma_f32_16x16x32_bf16 a[44:47], a[140:143], v[32:35], a[44:47]
    ds_read_b64_tr_b16 a[100:101], v56 offset:8
    v_mfma_f32_16x16x32_bf16 a[76:79], a[140:143], v[36:39], a[76:79]
    ds_read_b64_tr_b16 a[102:103], v56 offset:1032
    ds_read_b64_tr_b16 a[104:105], v57 offset:0
    v_mfma_f32_16x16x32_bf16 a[16:19], a[144:147], v[28:31], a[16:19]
    ds_read_b64_tr_b16 a[106:107], v57 offset:1024
    v_mfma_f32_16x16x32_bf16 a[48:51], a[144:147], v[32:35], a[48:51]
    ds_read_b64_tr_b16 a[108:109], v57 offset:8
    ds_read_b64_tr_b16 a[110:111], v57 offset:1032
    v_mfma_f32_16x16x32_bf16 a[80:83], a[144:147], v[36:39], a[80:83]
    ds_read_b64_tr_b16 a[112:113], v58 offset:0
    v_mfma_f32_16x16x32_bf16 a[20:23], a[148:151], v[28:31], a[20:23]
    ds_read_b64_tr_b16 a[114:115], v58 offset:1024
    v_mfma_f32_16x16x32_bf16 a[52:55], a[148:151], v[32:35], a[52:55]
    ds_read_b64_tr_b16 a[116:117], v58 offset:8
    ds_read_b64_tr_b16 a[118:119], v58 offset:1032
    s_add_u32 s47, s46, 11
    s_and_b32 s47, s47, 15
    v_mfma_f32_16x16x32_bf16 a[84:87], a[148:151], v[36:39], a[84:87]
    ds_read_b64_tr_b16 a[120:121], v59 offset:0
    s_lshl_b32 s47, s47, 6
    v_mfma_f32_16x16x32_bf16 a[24:27], a[152:155], v[28:31], a[24:27]
    ds_read_b64_tr_b16 a[122:123], v59 offset:1024
    ds_read_b64_tr_b16 a[124:125], v59 offset:8
    buffer_load_dwordx4 v[124:127], v10, s[20:23], s47 offen
    v_mfma_f32_16x16x32_bf16 a[56:59], a[152:155], v[32:35], a[56:59]
    ds_read_b64_tr_b16 a[126:127], v59 offset:1032
    v_mfma_f32_16x16x32_bf16 a[88:91], a[152:155], v[36:39], a[88:91]
    buffer_load_dwordx4 v[128:131], v11, s[20:23], s47 offen
    v_mfma_f32_16x16x32_bf16 a[28:31], a[156:159], v[28:31], a[28:31]
    v_mfma_f32_16x16x32_bf16 a[60:63], a[156:159], v[32:35], a[60:63]
    buffer_load_dwordx4 v[132:135], v12, s[20:23], s47 offen
    v_mfma_f32_16x16x32_bf16 a[92:95], a[156:159], v[36:39], a[92:95]
    s_waitcnt lgkmcnt(0) vmcnt(6)
    s_barrier
    v_mfma_f32_16x16x32_bf16 a[0:3], a[96:99], v[16:19], a[0:3]
    ds_bpermute_b32 v28, v13, v100
    v_mfma_f32_16x16x32_bf16 a[32:35], a[96:99], v[20:23], a[32:35]
    ds_bpermute_b32 v29, v13, v101
    ds_bpermute_b32 v30, v13, v102
    v_mfma_f32_16x16x32_bf16 a[64:67], a[96:99], v[24:27], a[64:67]
    ds_bpermute_b32 v31, v13, v103
    v_mfma_f32_16x16x32_bf16 a[4:7], a[100:103], v[16:19], a[4:7]
    ds_bpermute_b32 v32, v13, v104
    ds_bpermute_b32 v33, v13, v105
    v_mfma_f32_16x16x32_bf16 a[36:39], a[100:103], v[20:23], a[36:39]
    ds_bpermute_b32 v34, v13, v106
    v_mfma_f32_16x16x32_bf16 a[68:71], a[100:103], v[24:27], a[68:71]
    ds_bpermute_b32 v35, v13, v107
    v_mfma_f32_16x16x32_bf16 a[8:11], a[104:107], v[16:19], a[8:11]
    ds_bpermute_b32 v36, v13, v108
    ds_bpermute_b32 v37, v13, v109
    v_mfma_f32_16x16x32_bf16 a[40:43], a[104:107], v[20:23], a[40:43]
    ds_bpermute_b32 v38, v13, v110
    v_mfma_f32_16x16x32_bf16 a[72:75], a[104:107], v[24:27], a[72:75]
    ds_bpermute_b32 v39, v13, v111
    ds_read_b64_tr_b16 a[128:129], v56 offset:8192
    v_mfma_f32_16x16x32_bf16 a[12:15], a[108:111], v[16:19], a[12:15]
    ds_read_b64_tr_b16 a[130:131], v56 offset:9216
    v_mfma_f32_16x16x32_bf16 a[44:47], a[108:111], v[20:23], a[44:47]
    ds_read_b64_tr_b16 a[132:133], v56 offset:8200
    v_mfma_f32_16x16x32_bf16 a[76:79], a[108:111], v[24:27], a[76:79]
    ds_read_b64_tr_b16 a[134:135], v56 offset:9224
    ds_read_b64_tr_b16 a[136:137], v57 offset:8192
    v_mfma_f32_16x16x32_bf16 a[16:19], a[112:115], v[16:19], a[16:19]
    ds_read_b64_tr_b16 a[138:139], v57 offset:9216
    v_mfma_f32_16x16x32_bf16 a[48:51], a[112:115], v[20:23], a[48:51]
    ds_read_b64_tr_b16 a[140:141], v57 offset:8200
    ds_read_b64_tr_b16 a[142:143], v57 offset:9224
    v_mfma_f32_16x16x32_bf16 a[80:83], a[112:115], v[24:27], a[80:83]
    ds_read_b64_tr_b16 a[144:145], v58 offset:8192
    v_mfma_f32_16x16x32_bf16 a[20:23], a[116:119], v[16:19], a[20:23]
    ds_read_b64_tr_b16 a[146:147], v58 offset:9216
    v_mfma_f32_16x16x32_bf16 a[52:55], a[116:119], v[20:23], a[52:55]
    ds_read_b64_tr_b16 a[148:149], v58 offset:8200
    ds_read_b64_tr_b16 a[150:151], v58 offset:9224
    s_add_u32 s47, s46, 12
    s_and_b32 s47, s47, 15
    v_mfma_f32_16x16x32_bf16 a[84:87], a[116:119], v[24:27], a[84:87]
    ds_read_b64_tr_b16 a[152:153], v59 offset:8192
    s_lshl_b32 s47, s47, 6
    v_mfma_f32_16x16x32_bf16 a[24:27], a[120:123], v[16:19], a[24:27]
    ds_read_b64_tr_b16 a[154:155], v59 offset:9216
    ds_read_b64_tr_b16 a[156:157], v59 offset:8200
    buffer_load_dwordx4 v[64:67], v10, s[20:23], s47 offen
    v_mfma_f32_16x16x32_bf16 a[56:59], a[120:123], v[20:23], a[56:59]
    ds_read_b64_tr_b16 a[158:159], v59 offset:9224
    v_mfma_f32_16x16x32_bf16 a[88:91], a[120:123], v[24:27], a[88:91]
    buffer_load_dwordx4 v[68:71], v11, s[20:23], s47 offen
    v_mfma_f32_16x16x32_bf16 a[28:31], a[124:127], v[16:19], a[28:31]
    v_mfma_f32_16x16x32_bf16 a[60:63], a[124:127], v[20:23], a[60:63]
    buffer_load_dwordx4 v[72:75], v12, s[20:23], s47 offen
    v_mfma_f32_16x16x32_bf16 a[92:95], a[124:127], v[24:27], a[92:95]
    s_waitcnt lgkmcnt(0) vmcnt(6)
    s_barrier
    v_mfma_f32_16x16x32_bf16 a[0:3], a[128:131], v[28:31], a[0:3]
    ds_bpermute_b32 v16, v13, v112
    v_mfma_f32_16x16x32_bf16 a[32:35], a[128:131], v[32:35], a[32:35]
    ds_bpermute_b32 v17, v13, v113
    ds_bpermute_b32 v18, v13, v114
    v_mfma_f32_16x16x32_bf16 a[64:67], a[128:131], v[36:39], a[64:67]
    ds_bpermute_b32 v19, v13, v115
    v_mfma_f32_16x16x32_bf16 a[4:7], a[132:135], v[28:31], a[4:7]
    ds_bpermute_b32 v20, v13, v116
    ds_bpermute_b32 v21, v13, v117
    v_mfma_f32_16x16x32_bf16 a[36:39], a[132:135], v[32:35], a[36:39]
    ds_bpermute_b32 v22, v13, v118
    v_mfma_f32_16x16x32_bf16 a[68:71], a[132:135], v[36:39], a[68:71]
    ds_bpermute_b32 v23, v13, v119
    v_mfma_f32_16x16x32_bf16 a[8:11], a[136:139], v[28:31], a[8:11]
    ds_bpermute_b32 v24, v13, v120
    ds_bpermute_b32 v25, v13, v121
    v_mfma_f32_16x16x32_bf16 a[40:43], a[136:139], v[32:35], a[40:43]
    ds_bpermute_b32 v26, v13, v122
    v_mfma_f32_16x16x32_bf16 a[72:75], a[136:139], v[36:39], a[72:75]
    ds_bpermute_b32 v27, v13, v123
    ds_read_b64_tr_b16 a[96:97], v56 offset:16384
    v_mfma_f32_16x16x32_bf16 a[12:15], a[140:143], v[28:31], a[12:15]
    ds_read_b64_tr_b16 a[98:99], v56 offset:17408
    v_mfma_f32_16x16x32_bf16 a[44:47], a[140:143], v[32:35], a[44:47]
    ds_read_b64_tr_b16 a[100:101], v56 offset:16392
    v_mfma_f32_16x16x32_bf16 a[76:79], a[140:143], v[36:39], a[76:79]
    ds_read_b64_tr_b16 a[102:103], v56 offset:17416
    ds_read_b64_tr_b16 a[104:105], v57 offset:16384
    v_mfma_f32_16x16x32_bf16 a[16:19], a[144:147], v[28:31], a[16:19]
    ds_read_b64_tr_b16 a[106:107], v57 offset:17408
    v_mfma_f32_16x16x32_bf16 a[48:51], a[144:147], v[32:35], a[48:51]
    ds_read_b64_tr_b16 a[108:109], v57 offset:16392
    ds_read_b64_tr_b16 a[110:111], v57 offset:17416
    v_mfma_f32_16x16x32_bf16 a[80:83], a[144:147], v[36:39], a[80:83]
    ds_read_b64_tr_b16 a[112:113], v58 offset:16384
    v_mfma_f32_16x16x32_bf16 a[20:23], a[148:151], v[28:31], a[20:23]
    ds_read_b64_tr_b16 a[114:115], v58 offset:17408
    v_mfma_f32_16x16x32_bf16 a[52:55], a[148:151], v[32:35], a[52:55]
    ds_read_b64_tr_b16 a[116:117], v58 offset:16392
    ds_read_b64_tr_b16 a[118:119], v58 offset:17416
    s_add_u32 s47, s46, 13
    s_and_b32 s47, s47, 15
    v_mfma_f32_16x16x32_bf16 a[84:87], a[148:151], v[36:39], a[84:87]
    ds_read_b64_tr_b16 a[120:121], v59 offset:16384
    s_lshl_b32 s47, s47, 6
    v_mfma_f32_16x16x32_bf16 a[24:27], a[152:155], v[28:31], a[24:27]
    ds_read_b64_tr_b16 a[122:123], v59 offset:17408
    ds_read_b64_tr_b16 a[124:125], v59 offset:16392
    buffer_load_dwordx4 v[76:79], v10, s[20:23], s47 offen
    v_mfma_f32_16x16x32_bf16 a[56:59], a[152:155], v[32:35], a[56:59]
    ds_read_b64_tr_b16 a[126:127], v59 offset:17416
    v_mfma_f32_16x16x32_bf16 a[88:91], a[152:155], v[36:39], a[88:91]
    buffer_load_dwordx4 v[80:83], v11, s[20:23], s47 offen
    v_mfma_f32_16x16x32_bf16 a[28:31], a[156:159], v[28:31], a[28:31]
    v_mfma_f32_16x16x32_bf16 a[60:63], a[156:159], v[32:35], a[60:63]
    buffer_load_dwordx4 v[84:87], v12, s[20:23], s47 offen
    v_mfma_f32_16x16x32_bf16 a[92:95], a[156:159], v[36:39], a[92:95]
    s_waitcnt lgkmcnt(0) vmcnt(6)
    s_barrier
    v_mfma_f32_16x16x32_bf16 a[0:3], a[96:99], v[16:19], a[0:3]
    ds_bpermute_b32 v28, v13, v124
    v_mfma_f32_16x16x32_bf16 a[32:35], a[96:99], v[20:23], a[32:35]
    ds_bpermute_b32 v29, v13, v125
    ds_bpermute_b32 v30, v13, v126
    v_mfma_f32_16x16x32_bf16 a[64:67], a[96:99], v[24:27], a[64:67]
    ds_bpermute_b32 v31, v13, v127
    v_mfma_f32_16x16x32_bf16 a[4:7], a[100:103], v[16:19], a[4:7]
    ds_bpermute_b32 v32, v13, v128
    ds_bpermute_b32 v33, v13, v129
    v_mfma_f32_16x16x32_bf16 a[36:39], a[100:103], v[20:23], a[36:39]
    ds_bpermute_b32 v34, v13, v130
    v_mfma_f32_16x16x32_bf16 a[68:71], a[100:103], v[24:27], a[68:71]
    ds_bpermute_b32 v35, v13, v131
    v_mfma_f32_16x16x32_bf16 a[8:11], a[104:107], v[16:19], a[8:11]
    ds_bpermute_b32 v36, v13, v132
    ds_bpermute_b32 v37, v13, v133
    v_mfma_f32_16x16x32_bf16 a[40:43], a[104:107], v[20:23], a[40:43]
    ds_bpermute_b32 v38, v13, v134
    v_mfma_f32_16x16x32_bf16 a[72:75], a[104:107], v[24:27], a[72:75]
    ds_bpermute_b32 v39, v13, v135
    ds_read_b64_tr_b16 a[128:129], v56 offset:24576
    v_mfma_f32_16x16x32_bf16 a[12:15], a[108:111], v[16:19], a[12:15]
    ds_read_b64_tr_b16 a[130:131], v56 offset:25600
    v_mfma_f32_16x16x32_bf16 a[44:47], a[108:111], v[20:23], a[44:47]
    ds_read_b64_tr_b16 a[132:133], v56 offset:24584
    v_mfma_f32_16x16x32_bf16 a[76:79], a[108:111], v[24:27], a[76:79]
    ds_read_b64_tr_b16 a[134:135], v56 offset:25608
    ds_read_b64_tr_b16 a[136:137], v57 offset:24576
    v_mfma_f32_16x16x32_bf16 a[16:19], a[112:115], v[16:19], a[16:19]
    ds_read_b64_tr_b16 a[138:139], v57 offset:25600
    v_mfma_f32_16x16x32_bf16 a[48:51], a[112:115], v[20:23], a[48:51]
    ds_read_b64_tr_b16 a[140:141], v57 offset:24584
    ds_read_b64_tr_b16 a[142:143], v57 offset:25608
    v_mfma_f32_16x16x32_bf16 a[80:83], a[112:115], v[24:27], a[80:83]
    ds_read_b64_tr_b16 a[144:145], v58 offset:24576
    v_mfma_f32_16x16x32_bf16 a[20:23], a[116:119], v[16:19], a[20:23]
    ds_read_b64_tr_b16 a[146:147], v58 offset:25600
    v_mfma_f32_16x16x32_bf16 a[52:55], a[116:119], v[20:23], a[52:55]
    ds_read_b64_tr_b16 a[148:149], v58 offset:24584
    ds_read_b64_tr_b16 a[150:151], v58 offset:25608
    s_add_u32 s47, s46, 14
    s_and_b32 s47, s47, 15
    v_mfma_f32_16x16x32_bf16 a[84:87], a[116:119], v[24:27], a[84:87]
    ds_read_b64_tr_b16 a[152:153], v59 offset:24576
    s_lshl_b32 s47, s47, 6
    v_mfma_f32_16x16x32_bf16 a[24:27], a[120:123], v[16:19], a[24:27]
    ds_read_b64_tr_b16 a[154:155], v59 offset:25600
    ds_read_b64_tr_b16 a[156:157], v59 offset:24584
    buffer_load_dwordx4 v[88:91], v10, s[20:23], s47 offen
    v_mfma_f32_16x16x32_bf16 a[56:59], a[120:123], v[20:23], a[56:59]
    ds_read_b64_tr_b16 a[158:159], v59 offset:25608
    v_mfma_f32_16x16x32_bf16 a[88:91], a[120:123], v[24:27], a[88:91]
    buffer_load_dwordx4 v[92:95], v11, s[20:23], s47 offen
    v_mfma_f32_16x16x32_bf16 a[28:31], a[124:127], v[16:19], a[28:31]
    v_mfma_f32_16x16x32_bf16 a[60:63], a[124:127], v[20:23], a[60:63]
    buffer_load_dwordx4 v[96:99], v12, s[20:23], s47 offen
    v_mfma_f32_16x16x32_bf16 a[92:95], a[124:127], v[24:27], a[92:95]
    s_waitcnt lgkmcnt(0) vmcnt(6)
    s_barrier
    v_mfma_f32_16x16x32_bf16 a[0:3], a[128:131], v[28:31], a[0:3]
    ds_bpermute_b32 v16, v13, v64
    v_mfma_f32_16x16x32_bf16 a[32:35], a[128:131], v[32:35], a[32:35]
    ds_bpermute_b32 v17, v13, v65
    ds_bpermute_b32 v18, v13, v66
    v_mfma_f32_16x16x32_bf16 a[64:67], a[128:131], v[36:39], a[64:67]
    ds_bpermute_b32 v19, v13, v67
    v_mfma_f32_16x16x32_bf16 a[4:7], a[132:135], v[28:31], a[4:7]
    ds_bpermute_b32 v20, v13, v68
    ds_bpermute_b32 v21, v13, v69
    v_mfma_f32_16x16x32_bf16 a[36:39], a[132:135], v[32:35], a[36:39]
    ds_bpermute_b32 v22, v13, v70
    v_mfma_f32_16x16x32_bf16 a[68:71], a[132:135], v[36:39], a[68:71]
    ds_bpermute_b32 v23, v13, v71
    v_mfma_f32_16x16x32_bf16 a[8:11], a[136:139], v[28:31], a[8:11]
    ds_bpermute_b32 v24, v13, v72
    ds_bpermute_b32 v25, v13, v73
    v_mfma_f32_16x16x32_bf16 a[40:43], a[136:139], v[32:35], a[40:43]
    ds_bpermute_b32 v26, v13, v74
    v_mfma_f32_16x16x32_bf16 a[72:75], a[136:139], v[36:39], a[72:75]
    ds_bpermute_b32 v27, v13, v75
    ds_read_b64_tr_b16 a[96:97], v56 offset:32768
    v_mfma_f32_16x16x32_bf16 a[12:15], a[140:143], v[28:31], a[12:15]
    ds_read_b64_tr_b16 a[98:99], v56 offset:33792
    v_mfma_f32_16x16x32_bf16 a[44:47], a[140:143], v[32:35], a[44:47]
    ds_read_b64_tr_b16 a[100:101], v56 offset:32776
    v_mfma_f32_16x16x32_bf16 a[76:79], a[140:143], v[36:39], a[76:79]
    ds_read_b64_tr_b16 a[102:103], v56 offset:33800
    ds_read_b64_tr_b16 a[104:105], v57 offset:32768
    v_mfma_f32_16x16x32_bf16 a[16:19], a[144:147], v[28:31], a[16:19]
    ds_read_b64_tr_b16 a[106:107], v57 offset:33792
    v_mfma_f32_16x16x32_bf16 a[48:51], a[144:147], v[32:35], a[48:51]
    ds_read_b64_tr_b16 a[108:109], v57 offset:32776
    ds_read_b64_tr_b16 a[110:111], v57 offset:33800
    v_mfma_f32_16x16x32_bf16 a[80:83], a[144:147], v[36:39], a[80:83]
    ds_read_b64_tr_b16 a[112:113], v58 offset:32768
    v_mfma_f32_16x16x32_bf16 a[20:23], a[148:151], v[28:31], a[20:23]
    ds_read_b64_tr_b16 a[114:115], v58 offset:33792
    v_mfma_f32_16x16x32_bf16 a[52:55], a[148:151], v[32:35], a[52:55]
    ds_read_b64_tr_b16 a[116:117], v58 offset:32776
    ds_read_b64_tr_b16 a[118:119], v58 offset:33800
    s_add_u32 s47, s46, 15
    s_and_b32 s47, s47, 15
    v_mfma_f32_16x16x32_bf16 a[84:87], a[148:151], v[36:39], a[84:87]
    ds_read_b64_tr_b16 a[120:121], v59 offset:32768
    s_lshl_b32 s47, s47, 6
    v_mfma_f32_16x16x32_bf16 a[24:27], a[152:155], v[28:31], a[24:27]
    ds_read_b64_tr_b16 a[122:123], v59 offset:33792
    ds_read_b64_tr_b16 a[124:125], v59 offset:32776
    buffer_load_dwordx4 v[100:103], v10, s[20:23], s47 offen
    v_mfma_f32_16x16x32_bf16 a[56:59], a[152:155], v[32:35], a[56:59]
    ds_read_b64_tr_b16 a[126:127], v59 offset:33800
    v_mfma_f32_16x16x32_bf16 a[88:91], a[152:155], v[36:39], a[88:91]
    buffer_load_dwordx4 v[104:107], v11, s[20:23], s47 offen
    v_mfma_f32_16x16x32_bf16 a[28:31], a[156:159], v[28:31], a[28:31]
    v_mfma_f32_16x16x32_bf16 a[60:63], a[156:159], v[32:35], a[60:63]
    buffer_load_dwordx4 v[108:111], v12, s[20:23], s47 offen
    v_mfma_f32_16x16x32_bf16 a[92:95], a[156:159], v[36:39], a[92:95]
    s_waitcnt lgkmcnt(0) vmcnt(6)
    s_barrier
    v_mfma_f32_16x16x32_bf16 a[0:3], a[96:99], v[16:19], a[0:3]
    ds_bpermute_b32 v28, v13, v76
    v_mfma_f32_16x16x32_bf16 a[32:35], a[96:99], v[20:23], a[32:35]
    ds_bpermute_b32 v29, v13, v77
    ds_bpermute_b32 v30, v13, v78
    v_mfma_f32_16x16x32_bf16 a[64:67], a[96:99], v[24:27], a[64:67]
    ds_bpermute_b32 v31, v13, v79
    v_mfma_f32_16x16x32_bf16 a[4:7], a[100:103], v[16:19], a[4:7]
    ds_bpermute_b32 v32, v13, v80
    ds_bpermute_b32 v33, v13, v81
    v_mfma_f32_16x16x32_bf16 a[36:39], a[100:103], v[20:23], a[36:39]
    ds_bpermute_b32 v34, v13, v82
    v_mfma_f32_16x16x32_bf16 a[68:71], a[100:103], v[24:27], a[68:71]
    ds_bpermute_b32 v35, v13, v83
    v_mfma_f32_16x16x32_bf16 a[8:11], a[104:107], v[16:19], a[8:11]
    ds_bpermute_b32 v36, v13, v84
    ds_bpermute_b32 v37, v13, v85
    v_mfma_f32_16x16x32_bf16 a[40:43], a[104:107], v[20:23], a[40:43]
    ds_bpermute_b32 v38, v13, v86
    v_mfma_f32_16x16x32_bf16 a[72:75], a[104:107], v[24:27], a[72:75]
    ds_bpermute_b32 v39, v13, v87
    ds_read_b64_tr_b16 a[128:129], v56 offset:40960
    v_mfma_f32_16x16x32_bf16 a[12:15], a[108:111], v[16:19], a[12:15]
    ds_read_b64_tr_b16 a[130:131], v56 offset:41984
    v_mfma_f32_16x16x32_bf16 a[44:47], a[108:111], v[20:23], a[44:47]
    ds_read_b64_tr_b16 a[132:133], v56 offset:40968
    v_mfma_f32_16x16x32_bf16 a[76:79], a[108:111], v[24:27], a[76:79]
    ds_read_b64_tr_b16 a[134:135], v56 offset:41992
    ds_read_b64_tr_b16 a[136:137], v57 offset:40960
    v_mfma_f32_16x16x32_bf16 a[16:19], a[112:115], v[16:19], a[16:19]
    ds_read_b64_tr_b16 a[138:139], v57 offset:41984
    v_mfma_f32_16x16x32_bf16 a[48:51], a[112:115], v[20:23], a[48:51]
    ds_read_b64_tr_b16 a[140:141], v57 offset:40968
    ds_read_b64_tr_b16 a[142:143], v57 offset:41992
    v_mfma_f32_16x16x32_bf16 a[80:83], a[112:115], v[24:27], a[80:83]
    ds_read_b64_tr_b16 a[144:145], v58 offset:40960
    v_mfma_f32_16x16x32_bf16 a[20:23], a[116:119], v[16:19], a[20:23]
    ds_read_b64_tr_b16 a[146:147], v58 offset:41984
    v_mfma_f32_16x16x32_bf16 a[52:55], a[116:119], v[20:23], a[52:55]
    ds_read_b64_tr_b16 a[148:149], v58 offset:40968
    ds_read_b64_tr_b16 a[150:151], v58 offset:41992
    v_mfma_f32_16x16x32_bf16 a[84:87], a[116:119], v[24:27], a[84:87]
    ds_read_b64_tr_b16 a[152:153], v59 offset:40960
    v_mfma_f32_16x16x32_bf16 a[24:27], a[120:123], v[16:19], a[24:27]
    ds_read_b64_tr_b16 a[154:155], v59 offset:41984
    ds_read_b64_tr_b16 a[156:157], v59 offset:40968
    v_mfma_f32_16x16x32_bf16 a[56:59], a[120:123], v[20:23], a[56:59]
    ds_read_b64_tr_b16 a[158:159], v59 offset:41992
    v_mfma_f32_16x16x32_bf16 a[88:91], a[120:123], v[24:27], a[88:91]
    v_mfma_f32_16x16x32_bf16 a[28:31], a[124:127], v[16:19], a[28:31]
    v_mfma_f32_16x16x32_bf16 a[60:63], a[124:127], v[20:23], a[60:63]
    v_mfma_f32_16x16x32_bf16 a[92:95], a[124:127], v[24:27], a[92:95]
    s_waitcnt lgkmcnt(0) vmcnt(3)
    s_barrier
    v_mfma_f32_16x16x32_bf16 a[0:3], a[128:131], v[28:31], a[0:3]
    ds_bpermute_b32 v16, v13, v88
    v_mfma_f32_16x16x32_bf16 a[32:35], a[128:131], v[32:35], a[32:35]
    ds_bpermute_b32 v17, v13, v89
    ds_bpermute_b32 v18, v13, v90
    v_mfma_f32_16x16x32_bf16 a[64:67], a[128:131], v[36:39], a[64:67]
    ds_bpermute_b32 v19, v13, v91
    v_mfma_f32_16x16x32_bf16 a[4:7], a[132:135], v[28:31], a[4:7]
    ds_bpermute_b32 v20, v13, v92
    ds_bpermute_b32 v21, v13, v93
    v_mfma_f32_16x16x32_bf16 a[36:39], a[132:135], v[32:35], a[36:39]
    ds_bpermute_b32 v22, v13, v94
    v_mfma_f32_16x16x32_bf16 a[68:71], a[132:135], v[36:39], a[68:71]
    ds_bpermute_b32 v23, v13, v95
    v_mfma_f32_16x16x32_bf16 a[8:11], a[136:139], v[28:31], a[8:11]
    ds_bpermute_b32 v24, v13, v96
    ds_bpermute_b32 v25, v13, v97
    v_mfma_f32_16x16x32_bf16 a[40:43], a[136:139], v[32:35], a[40:43]
    ds_bpermute_b32 v26, v13, v98
    v_mfma_f32_16x16x32_bf16 a[72:75], a[136:139], v[36:39], a[72:75]
    ds_bpermute_b32 v27, v13, v99
    ds_read_b64_tr_b16 a[96:97], v56 offset:49152
    v_mfma_f32_16x16x32_bf16 a[12:15], a[140:143], v[28:31], a[12:15]
    ds_read_b64_tr_b16 a[98:99], v56 offset:50176
    v_mfma_f32_16x16x32_bf16 a[44:47], a[140:143], v[32:35], a[44:47]
    ds_read_b64_tr_b16 a[100:101], v56 offset:49160
    v_mfma_f32_16x16x32_bf16 a[76:79], a[140:143], v[36:39], a[76:79]
    ds_read_b64_tr_b16 a[102:103], v56 offset:50184
    ds_read_b64_tr_b16 a[104:105], v57 offset:49152
    v_mfma_f32_16x16x32_bf16 a[16:19], a[144:147], v[28:31], a[16:19]
    ds_read_b64_tr_b16 a[106:107], v57 offset:50176
    v_mfma_f32_16x16x32_bf16 a[48:51], a[144:147], v[32:35], a[48:51]
    ds_read_b64_tr_b16 a[108:109], v57 offset:49160
    ds_read_b64_tr_b16 a[110:111], v57 offset:50184
    v_mfma_f32_16x16x32_bf16 a[80:83], a[144:147], v[36:39], a[80:83]
    ds_read_b64_tr_b16 a[112:113], v58 offset:49152
    v_mfma_f32_16x16x32_bf16 a[20:23], a[148:151], v[28:31], a[20:23]
    ds_read_b64_tr_b16 a[114:115], v58 offset:50176
    v_mfma_f32_16x16x32_bf16 a[52:55], a[148:151], v[32:35], a[52:55]
    ds_read_b64_tr_b16 a[116:117], v58 offset:49160
    ds_read_b64_tr_b16 a[118:119], v58 offset:50184
    v_mfma_f32_16x16x32_bf16 a[84:87], a[148:151], v[36:39], a[84:87]
    ds_read_b64_tr_b16 a[120:121], v59 offset:49152
    v_mfma_f32_16x16x32_bf16 a[24:27], a[152:155], v[28:31], a[24:27]
    ds_read_b64_tr_b16 a[122:123], v59 offset:50176
    ds_read_b64_tr_b16 a[124:125], v59 offset:49160
    v_mfma_f32_16x16x32_bf16 a[56:59], a[152:155], v[32:35], a[56:59]
    ds_read_b64_tr_b16 a[126:127], v59 offset:50184
    v_mfma_f32_16x16x32_bf16 a[88:91], a[152:155], v[36:39], a[88:91]
    v_mfma_f32_16x16x32_bf16 a[28:31], a[156:159], v[28:31], a[28:31]
    v_mfma_f32_16x16x32_bf16 a[60:63], a[156:159], v[32:35], a[60:63]
    v_mfma_f32_16x16x32_bf16 a[92:95], a[156:159], v[36:39], a[92:95]
    s_waitcnt lgkmcnt(0) vmcnt(0)
    s_barrier
    v_mfma_f32_16x16x32_bf16 a[0:3], a[96:99], v[16:19], a[0:3]
    ds_bpermute_b32 v28, v13, v100
    v_mfma_f32_16x16x32_bf16 a[32:35], a[96:99], v[20:23], a[32:35]
    ds_bpermute_b32 v29, v13, v101
    ds_bpermute_b32 v30, v13, v102
    v_mfma_f32_16x16x32_bf16 a[64:67], a[96:99], v[24:27], a[64:67]
    ds_bpermute_b32 v31, v13, v103
    v_mfma_f32_16x16x32_bf16 a[4:7], a[100:103], v[16:19], a[4:7]
    ds_bpermute_b32 v32, v13, v104
    ds_bpermute_b32 v33, v13, v105
    v_mfma_f32_16x16x32_bf16 a[36:39], a[100:103], v[20:23], a[36:39]
    ds_bpermute_b32 v34, v13, v106
    v_mfma_f32_16x16x32_bf16 a[68:71], a[100:103], v[24:27], a[68:71]
    ds_bpermute_b32 v35, v13, v107
    v_mfma_f32_16x16x32_bf16 a[8:11], a[104:107], v[16:19], a[8:11]
    ds_bpermute_b32 v36, v13, v108
    ds_bpermute_b32 v37, v13, v109
    v_mfma_f32_16x16x32_bf16 a[40:43], a[104:107], v[20:23], a[40:43]
    ds_bpermute_b32 v38, v13, v110
    v_mfma_f32_16x16x32_bf16 a[72:75], a[104:107], v[24:27], a[72:75]
    ds_bpermute_b32 v39, v13, v111
    ds_read_b64_tr_b16 a[128:129], v56 offset:57344
    v_mfma_f32_16x16x32_bf16 a[12:15], a[108:111], v[16:19], a[12:15]
    ds_read_b64_tr_b16 a[130:131], v56 offset:58368
    v_mfma_f32_16x16x32_bf16 a[44:47], a[108:111], v[20:23], a[44:47]
    ds_read_b64_tr_b16 a[132:133], v56 offset:57352
    v_mfma_f32_16x16x32_bf16 a[76:79], a[108:111], v[24:27], a[76:79]
    ds_read_b64_tr_b16 a[134:135], v56 offset:58376
    ds_read_b64_tr_b16 a[136:137], v57 offset:57344
    v_mfma_f32_16x16x32_bf16 a[16:19], a[112:115], v[16:19], a[16:19]
    ds_read_b64_tr_b16 a[138:139], v57 offset:58368
    v_mfma_f32_16x16x32_bf16 a[48:51], a[112:115], v[20:23], a[48:51]
    ds_read_b64_tr_b16 a[140:141], v57 offset:57352
    ds_read_b64_tr_b16 a[142:143], v57 offset:58376
    v_mfma_f32_16x16x32_bf16 a[80:83], a[112:115], v[24:27], a[80:83]
    ds_read_b64_tr_b16 a[144:145], v58 offset:57344
    v_mfma_f32_16x16x32_bf16 a[20:23], a[116:119], v[16:19], a[20:23]
    ds_read_b64_tr_b16 a[146:147], v58 offset:58368
    v_mfma_f32_16x16x32_bf16 a[52:55], a[116:119], v[20:23], a[52:55]
    ds_read_b64_tr_b16 a[148:149], v58 offset:57352
    ds_read_b64_tr_b16 a[150:151], v58 offset:58376
    v_mfma_f32_16x16x32_bf16 a[84:87], a[116:119], v[24:27], a[84:87]
    ds_read_b64_tr_b16 a[152:153], v59 offset:57344
    v_mfma_f32_16x16x32_bf16 a[24:27], a[120:123], v[16:19], a[24:27]
    ds_read_b64_tr_b16 a[154:155], v59 offset:58368
    ds_read_b64_tr_b16 a[156:157], v59 offset:57352
    v_mfma_f32_16x16x32_bf16 a[56:59], a[120:123], v[20:23], a[56:59]
    ds_read_b64_tr_b16 a[158:159], v59 offset:58376
    v_mfma_f32_16x16x32_bf16 a[88:91], a[120:123], v[24:27], a[88:91]
    v_mfma_f32_16x16x32_bf16 a[28:31], a[124:127], v[16:19], a[28:31]
    v_mfma_f32_16x16x32_bf16 a[60:63], a[124:127], v[20:23], a[60:63]
    v_mfma_f32_16x16x32_bf16 a[92:95], a[124:127], v[24:27], a[92:95]
    s_waitcnt lgkmcnt(0) vmcnt(0)
    s_barrier
    v_mfma_f32_16x16x32_bf16 a[0:3], a[128:131], v[28:31], a[0:3]
    v_mfma_f32_16x16x32_bf16 a[32:35], a[128:131], v[32:35], a[32:35]
    v_mfma_f32_16x16x32_bf16 a[64:67], a[128:131], v[36:39], a[64:67]
    v_mfma_f32_16x16x32_bf16 a[4:7], a[132:135], v[28:31], a[4:7]
    v_mfma_f32_16x16x32_bf16 a[36:39], a[132:135], v[32:35], a[36:39]
    v_mfma_f32_16x16x32_bf16 a[68:71], a[132:135], v[36:39], a[68:71]
    v_mfma_f32_16x16x32_bf16 a[8:11], a[136:139], v[28:31], a[8:11]
    v_mfma_f32_16x16x32_bf16 a[40:43], a[136:139], v[32:35], a[40:43]
    v_mfma_f32_16x16x32_bf16 a[72:75], a[136:139], v[36:39], a[72:75]
    v_mfma_f32_16x16x32_bf16 a[12:15], a[140:143], v[28:31], a[12:15]
    v_mfma_f32_16x16x32_bf16 a[44:47], a[140:143], v[32:35], a[44:47]
    v_mfma_f32_16x16x32_bf16 a[76:79], a[140:143], v[36:39], a[76:79]
    v_mfma_f32_16x16x32_bf16 a[16:19], a[144:147], v[28:31], a[16:19]
    v_mfma_f32_16x16x32_bf16 a[48:51], a[144:147], v[32:35], a[48:51]
    v_mfma_f32_16x16x32_bf16 a[80:83], a[144:147], v[36:39], a[80:83]
    v_mfma_f32_16x16x32_bf16 a[20:23], a[148:151], v[28:31], a[20:23]
    v_mfma_f32_16x16x32_bf16 a[52:55], a[148:151], v[32:35], a[52:55]
    v_mfma_f32_16x16x32_bf16 a[84:87], a[148:151], v[36:39], a[84:87]
    v_mfma_f32_16x16x32_bf16 a[24:27], a[152:155], v[28:31], a[24:27]
    v_mfma_f32_16x16x32_bf16 a[56:59], a[152:155], v[32:35], a[56:59]
    v_mfma_f32_16x16x32_bf16 a[88:91], a[152:155], v[36:39], a[88:91]
    v_mfma_f32_16x16x32_bf16 a[28:31], a[156:159], v[28:31], a[28:31]
    v_mfma_f32_16x16x32_bf16 a[60:63], a[156:159], v[32:35], a[60:63]
    v_mfma_f32_16x16x32_bf16 a[92:95], a[156:159], v[36:39], a[92:95]
    s_nop 7
    v_accvgpr_read_b32 v8, a0
    v_accvgpr_read_b32 v9, a1
    v_mul_f32 v8, 0x3e0293ee, v8
    v_mul_f32 v9, 0x3e0293ee, v9
    v_cvt_pk_bf16_f32 v16, v8, v9
    v_accvgpr_read_b32 v8, a2
    v_accvgpr_read_b32 v9, a3
    v_mul_f32 v8, 0x3e0293ee, v8
    v_mul_f32 v9, 0x3e0293ee, v9
    v_cvt_pk_bf16_f32 v17, v8, v9
    v_accvgpr_read_b32 v8, a4
    v_accvgpr_read_b32 v9, a5
    v_mul_f32 v8, 0x3e0293ee, v8
    v_mul_f32 v9, 0x3e0293ee, v9
    v_cvt_pk_bf16_f32 v18, v8, v9
    v_accvgpr_read_b32 v8, a6
    v_accvgpr_read_b32 v9, a7
    v_mul_f32 v8, 0x3e0293ee, v8
    v_mul_f32 v9, 0x3e0293ee, v9
    v_cvt_pk_bf16_f32 v19, v8, v9
    v_accvgpr_read_b32 v8, a8
    v_accvgpr_read_b32 v9, a9
    v_mul_f32 v8, 0x3e0293ee, v8
    v_mul_f32 v9, 0x3e0293ee, v9
    v_cvt_pk_bf16_f32 v20, v8, v9
    v_accvgpr_read_b32 v8, a10
    v_accvgpr_read_b32 v9, a11
    v_mul_f32 v8, 0x3e0293ee, v8
    v_mul_f32 v9, 0x3e0293ee, v9
    v_cvt_pk_bf16_f32 v21, v8, v9
    v_accvgpr_read_b32 v8, a12
    v_accvgpr_read_b32 v9, a13
    v_mul_f32 v8, 0x3e0293ee, v8
    v_mul_f32 v9, 0x3e0293ee, v9
    v_cvt_pk_bf16_f32 v22, v8, v9
    v_accvgpr_read_b32 v8, a14
    v_accvgpr_read_b32 v9, a15
    v_mul_f32 v8, 0x3e0293ee, v8
    v_mul_f32 v9, 0x3e0293ee, v9
    v_cvt_pk_bf16_f32 v23, v8, v9
    v_accvgpr_read_b32 v8, a16
    v_accvgpr_read_b32 v9, a17
    v_mul_f32 v8, 0x3e0293ee, v8
    v_mul_f32 v9, 0x3e0293ee, v9
    v_cvt_pk_bf16_f32 v24, v8, v9
    v_accvgpr_read_b32 v8, a18
    v_accvgpr_read_b32 v9, a19
    v_mul_f32 v8, 0x3e0293ee, v8
    v_mul_f32 v9, 0x3e0293ee, v9
    v_cvt_pk_bf16_f32 v25, v8, v9
    v_accvgpr_read_b32 v8, a20
    v_accvgpr_read_b32 v9, a21
    v_mul_f32 v8, 0x3e0293ee, v8
    v_mul_f32 v9, 0x3e0293ee, v9
    v_cvt_pk_bf16_f32 v26, v8, v9
    v_accvgpr_read_b32 v8, a22
    v_accvgpr_read_b32 v9, a23
    v_mul_f32 v8, 0x3e0293ee, v8
    v_mul_f32 v9, 0x3e0293ee, v9
    v_cvt_pk_bf16_f32 v27, v8, v9
    v_accvgpr_read_b32 v8, a24
    v_accvgpr_read_b32 v9, a25
    v_mul_f32 v8, 0x3e0293ee, v8
    v_mul_f32 v9, 0x3e0293ee, v9
    v_cvt_pk_bf16_f32 v28, v8, v9
    v_accvgpr_read_b32 v8, a26
    v_accvgpr_read_b32 v9, a27
    v_mul_f32 v8, 0x3e0293ee, v8
    v_mul_f32 v9, 0x3e0293ee, v9
    v_cvt_pk_bf16_f32 v29, v8, v9
    v_accvgpr_read_b32 v8, a28
    v_accvgpr_read_b32 v9, a29
    v_mul_f32 v8, 0x3e0293ee, v8
    v_mul_f32 v9, 0x3e0293ee, v9
    v_cvt_pk_bf16_f32 v30, v8, v9
    v_accvgpr_read_b32 v8, a30
    v_accvgpr_read_b32 v9, a31
    v_mul_f32 v8, 0x3e0293ee, v8
    v_mul_f32 v9, 0x3e0293ee, v9
    v_cvt_pk_bf16_f32 v31, v8, v9
    v_accvgpr_read_b32 v8, a32
    v_accvgpr_read_b32 v9, a33
    v_mul_f32 v8, 0x3e0293ee, v8
    v_mul_f32 v9, 0x3e0293ee, v9
    v_cvt_pk_bf16_f32 v32, v8, v9
    v_accvgpr_read_b32 v8, a34
    v_accvgpr_read_b32 v9, a35
    v_mul_f32 v8, 0x3e0293ee, v8
    v_mul_f32 v9, 0x3e0293ee, v9
    v_cvt_pk_bf16_f32 v33, v8, v9
    v_accvgpr_read_b32 v8, a36
    v_accvgpr_read_b32 v9, a37
    v_mul_f32 v8, 0x3e0293ee, v8
    v_mul_f32 v9, 0x3e0293ee, v9
    v_cvt_pk_bf16_f32 v34, v8, v9
    v_accvgpr_read_b32 v8, a38
    v_accvgpr_read_b32 v9, a39
    v_mul_f32 v8, 0x3e0293ee, v8
    v_mul_f32 v9, 0x3e0293ee, v9
    v_cvt_pk_bf16_f32 v35, v8, v9
    v_accvgpr_read_b32 v8, a40
    v_accvgpr_read_b32 v9, a41
    v_mul_f32 v8, 0x3e0293ee, v8
    v_mul_f32 v9, 0x3e0293ee, v9
    v_cvt_pk_bf16_f32 v36, v8, v9
    v_accvgpr_read_b32 v8, a42
    v_accvgpr_read_b32 v9, a43
    v_mul_f32 v8, 0x3e0293ee, v8
    v_mul_f32 v9, 0x3e0293ee, v9
    v_cvt_pk_bf16_f32 v37, v8, v9
    v_accvgpr_read_b32 v8, a44
    v_accvgpr_read_b32 v9, a45
    v_mul_f32 v8, 0x3e0293ee, v8
    v_mul_f32 v9, 0x3e0293ee, v9
    v_cvt_pk_bf16_f32 v38, v8, v9
    v_accvgpr_read_b32 v8, a46
    v_accvgpr_read_b32 v9, a47
    v_mul_f32 v8, 0x3e0293ee, v8
    v_mul_f32 v9, 0x3e0293ee, v9
    v_cvt_pk_bf16_f32 v39, v8, v9
    v_accvgpr_read_b32 v8, a48
    v_accvgpr_read_b32 v9, a49
    v_mul_f32 v8, 0x3e0293ee, v8
    v_mul_f32 v9, 0x3e0293ee, v9
    v_cvt_pk_bf16_f32 v40, v8, v9
    v_accvgpr_read_b32 v8, a50
    v_accvgpr_read_b32 v9, a51
    v_mul_f32 v8, 0x3e0293ee, v8
    v_mul_f32 v9, 0x3e0293ee, v9
    v_cvt_pk_bf16_f32 v41, v8, v9
    v_accvgpr_read_b32 v8, a52
    v_accvgpr_read_b32 v9, a53
    v_mul_f32 v8, 0x3e0293ee, v8
    v_mul_f32 v9, 0x3e0293ee, v9
    v_cvt_pk_bf16_f32 v42, v8, v9
    v_accvgpr_read_b32 v8, a54
    v_accvgpr_read_b32 v9, a55
    v_mul_f32 v8, 0x3e0293ee, v8
    v_mul_f32 v9, 0x3e0293ee, v9
    v_cvt_pk_bf16_f32 v43, v8, v9
    v_accvgpr_read_b32 v8, a56
    v_accvgpr_read_b32 v9, a57
    v_mul_f32 v8, 0x3e0293ee, v8
    v_mul_f32 v9, 0x3e0293ee, v9
    v_cvt_pk_bf16_f32 v44, v8, v9
    v_accvgpr_read_b32 v8, a58
    v_accvgpr_read_b32 v9, a59
    v_mul_f32 v8, 0x3e0293ee, v8
    v_mul_f32 v9, 0x3e0293ee, v9
    v_cvt_pk_bf16_f32 v45, v8, v9
    v_accvgpr_read_b32 v8, a60
    v_accvgpr_read_b32 v9, a61
    v_mul_f32 v8, 0x3e0293ee, v8
    v_mul_f32 v9, 0x3e0293ee, v9
    v_cvt_pk_bf16_f32 v46, v8, v9
    v_accvgpr_read_b32 v8, a62
    v_accvgpr_read_b32 v9, a63
    v_mul_f32 v8, 0x3e0293ee, v8
    v_mul_f32 v9, 0x3e0293ee, v9
    v_cvt_pk_bf16_f32 v47, v8, v9
    v_accvgpr_read_b32 v8, a64
    v_accvgpr_read_b32 v9, a65
    v_mul_f32 v8, 0x3e0293ee, v8
    v_mul_f32 v9, 0x3e0293ee, v9
    v_cvt_pk_bf16_f32 v48, v8, v9
    v_accvgpr_read_b32 v8, a66
    v_accvgpr_read_b32 v9, a67
    v_mul_f32 v8, 0x3e0293ee, v8
    v_mul_f32 v9, 0x3e0293ee, v9
    v_cvt_pk_bf16_f32 v49, v8, v9
    v_accvgpr_read_b32 v8, a68
    v_accvgpr_read_b32 v9, a69
    v_mul_f32 v8, 0x3e0293ee, v8
    v_mul_f32 v9, 0x3e0293ee, v9
    v_cvt_pk_bf16_f32 v50, v8, v9
    v_accvgpr_read_b32 v8, a70
    v_accvgpr_read_b32 v9, a71
    v_mul_f32 v8, 0x3e0293ee, v8
    v_mul_f32 v9, 0x3e0293ee, v9
    v_cvt_pk_bf16_f32 v51, v8, v9
    v_accvgpr_read_b32 v8, a72
    v_accvgpr_read_b32 v9, a73
    v_mul_f32 v8, 0x3e0293ee, v8
    v_mul_f32 v9, 0x3e0293ee, v9
    v_cvt_pk_bf16_f32 v52, v8, v9
    v_accvgpr_read_b32 v8, a74
    v_accvgpr_read_b32 v9, a75
    v_mul_f32 v8, 0x3e0293ee, v8
    v_mul_f32 v9, 0x3e0293ee, v9
    v_cvt_pk_bf16_f32 v53, v8, v9
    v_accvgpr_read_b32 v8, a76
    v_accvgpr_read_b32 v9, a77
    v_mul_f32 v8, 0x3e0293ee, v8
    v_mul_f32 v9, 0x3e0293ee, v9
    v_cvt_pk_bf16_f32 v54, v8, v9
    v_accvgpr_read_b32 v8, a78
    v_accvgpr_read_b32 v9, a79
    v_mul_f32 v8, 0x3e0293ee, v8
    v_mul_f32 v9, 0x3e0293ee, v9
    v_cvt_pk_bf16_f32 v55, v8, v9
    v_accvgpr_read_b32 v8, a80
    v_accvgpr_read_b32 v9, a81
    v_mul_f32 v8, 0x3e0293ee, v8
    v_mul_f32 v9, 0x3e0293ee, v9
    v_cvt_pk_bf16_f32 v56, v8, v9
    v_accvgpr_read_b32 v8, a82
    v_accvgpr_read_b32 v9, a83
    v_mul_f32 v8, 0x3e0293ee, v8
    v_mul_f32 v9, 0x3e0293ee, v9
    v_cvt_pk_bf16_f32 v57, v8, v9
    v_accvgpr_read_b32 v8, a84
    v_accvgpr_read_b32 v9, a85
    v_mul_f32 v8, 0x3e0293ee, v8
    v_mul_f32 v9, 0x3e0293ee, v9
    v_cvt_pk_bf16_f32 v58, v8, v9
    v_accvgpr_read_b32 v8, a86
    v_accvgpr_read_b32 v9, a87
    v_mul_f32 v8, 0x3e0293ee, v8
    v_mul_f32 v9, 0x3e0293ee, v9
    v_cvt_pk_bf16_f32 v59, v8, v9
    v_accvgpr_read_b32 v8, a88
    v_accvgpr_read_b32 v9, a89
    v_mul_f32 v8, 0x3e0293ee, v8
    v_mul_f32 v9, 0x3e0293ee, v9
    v_cvt_pk_bf16_f32 v60, v8, v9
    v_accvgpr_read_b32 v8, a90
    v_accvgpr_read_b32 v9, a91
    v_mul_f32 v8, 0x3e0293ee, v8
    v_mul_f32 v9, 0x3e0293ee, v9
    v_cvt_pk_bf16_f32 v61, v8, v9
    v_accvgpr_read_b32 v8, a92
    v_accvgpr_read_b32 v9, a93
    v_mul_f32 v8, 0x3e0293ee, v8
    v_mul_f32 v9, 0x3e0293ee, v9
    v_cvt_pk_bf16_f32 v62, v8, v9
    v_accvgpr_read_b32 v8, a94
    v_accvgpr_read_b32 v9, a95
    v_mul_f32 v8, 0x3e0293ee, v8
    v_mul_f32 v9, 0x3e0293ee, v9
    v_cvt_pk_bf16_f32 v63, v8, v9
    s_waitcnt vmcnt(0)
    v_accvgpr_write_b32 a0, 0
    v_accvgpr_write_b32 a1, 0
    v_accvgpr_write_b32 a2, 0
    v_accvgpr_write_b32 a3, 0
    v_accvgpr_write_b32 a4, 0
    v_accvgpr_write_b32 a5, 0
    v_accvgpr_write_b32 a6, 0
    v_accvgpr_write_b32 a7, 0
    v_accvgpr_write_b32 a8, 0
    v_accvgpr_write_b32 a9, 0
    v_accvgpr_write_b32 a10, 0
    v_accvgpr_write_b32 a11, 0
    v_accvgpr_write_b32 a12, 0
    v_accvgpr_write_b32 a13, 0
    v_accvgpr_write_b32 a14, 0
    v_accvgpr_write_b32 a15, 0
    v_accvgpr_write_b32 a16, 0
    v_accvgpr_write_b32 a17, 0
    v_accvgpr_write_b32 a18, 0
    v_accvgpr_write_b32 a19, 0
    v_accvgpr_write_b32 a20, 0
    v_accvgpr_write_b32 a21, 0
    v_accvgpr_write_b32 a22, 0
    v_accvgpr_write_b32 a23, 0
    v_accvgpr_write_b32 a24, 0
    v_accvgpr_write_b32 a25, 0
    v_accvgpr_write_b32 a26, 0
    v_accvgpr_write_b32 a27, 0
    v_accvgpr_write_b32 a28, 0
    v_accvgpr_write_b32 a29, 0
    v_accvgpr_write_b32 a30, 0
    v_accvgpr_write_b32 a31, 0
    v_accvgpr_write_b32 a32, 0
    v_accvgpr_write_b32 a33, 0
    v_accvgpr_write_b32 a34, 0
    v_accvgpr_write_b32 a35, 0
    v_accvgpr_write_b32 a36, 0
    v_accvgpr_write_b32 a37, 0
    v_accvgpr_write_b32 a38, 0
    v_accvgpr_write_b32 a39, 0
    v_accvgpr_write_b32 a40, 0
    v_accvgpr_write_b32 a41, 0
    v_accvgpr_write_b32 a42, 0
    v_accvgpr_write_b32 a43, 0
    v_accvgpr_write_b32 a44, 0
    v_accvgpr_write_b32 a45, 0
    v_accvgpr_write_b32 a46, 0
    v_accvgpr_write_b32 a47, 0
    v_accvgpr_write_b32 a48, 0
    v_accvgpr_write_b32 a49, 0
    v_accvgpr_write_b32 a50, 0
    v_accvgpr_write_b32 a51, 0
    v_accvgpr_write_b32 a52, 0
    v_accvgpr_write_b32 a53, 0
    v_accvgpr_write_b32 a54, 0
    v_accvgpr_write_b32 a55, 0
    v_accvgpr_write_b32 a56, 0
    v_accvgpr_write_b32 a57, 0
    v_accvgpr_write_b32 a58, 0
    v_accvgpr_write_b32 a59, 0
    v_accvgpr_write_b32 a60, 0
    v_accvgpr_write_b32 a61, 0
    v_accvgpr_write_b32 a62, 0
    v_accvgpr_write_b32 a63, 0
    v_accvgpr_write_b32 a64, 0
    v_accvgpr_write_b32 a65, 0
    v_accvgpr_write_b32 a66, 0
    v_accvgpr_write_b32 a67, 0
    v_accvgpr_write_b32 a68, 0
    v_accvgpr_write_b32 a69, 0
    v_accvgpr_write_b32 a70, 0
    v_accvgpr_write_b32 a71, 0
    v_accvgpr_write_b32 a72, 0
    v_accvgpr_write_b32 a73, 0
    v_accvgpr_write_b32 a74, 0
    v_accvgpr_write_b32 a75, 0
    v_accvgpr_write_b32 a76, 0
    v_accvgpr_write_b32 a77, 0
    v_accvgpr_write_b32 a78, 0
    v_accvgpr_write_b32 a79, 0
    v_accvgpr_write_b32 a80, 0
    v_accvgpr_write_b32 a81, 0
    v_accvgpr_write_b32 a82, 0
    v_accvgpr_write_b32 a83, 0
    v_accvgpr_write_b32 a84, 0
    v_accvgpr_write_b32 a85, 0
    v_accvgpr_write_b32 a86, 0
    v_accvgpr_write_b32 a87, 0
    v_accvgpr_write_b32 a88, 0
    v_accvgpr_write_b32 a89, 0
    v_accvgpr_write_b32 a90, 0
    v_accvgpr_write_b32 a91, 0
    v_accvgpr_write_b32 a92, 0
    v_accvgpr_write_b32 a93, 0
    v_accvgpr_write_b32 a94, 0
    v_accvgpr_write_b32 a95, 0
    s_mov_b32 s50, 0x44800000
    s_mov_b32 s17, 0
    s_mov_b32 s18, 0
    v_mov_b32 v160, v172
    v_mov_b32 v161, v173
    v_mov_b32 v162, v174
    v_mov_b32 v163, v175
    s_barrier
    ds_read_b128 a[96:99], v160 offset:0
    ds_read_b128 a[100:103], v161 offset:0
    ds_read_b128 a[104:107], v162 offset:0
    ds_read_b128 a[108:111], v163 offset:0
    ds_read_b128 a[112:115], v160 offset:4096
    ds_read_b128 a[116:119], v161 offset:4096
    ds_read_b128 a[120:123], v162 offset:4096
    ds_read_b128 a[124:127], v163 offset:4096
    ds_read_b128 a[128:131], v160 offset:8192
    ds_read_b128 a[132:135], v161 offset:8192
    ds_read_b128 a[136:139], v162 offset:8192
    ds_read_b128 a[140:143], v163 offset:8192
    s_waitcnt lgkmcnt(0)
A_LOOP:
    s_waitcnt lgkmcnt(4)
    v_mfma_f32_16x16x32_bf16 v[64:67], a[96:99], v[16:19], v[136:139]
    ds_read_b128 a[144:147], v160 offset:12288
    v_add_f32 v252, v224, v225
    v_mfma_f32_16x16x32_bf16 v[64:67], a[100:103], v[20:23], v[64:67]
    v_add_f32 v253, v226, v227
    v_add_f32 v254, v228, v229
    v_mfma_f32_16x16x32_bf16 v[64:67], a[104:107], v[24:27], v[64:67]
    ds_read_b128 a[148:151], v161 offset:12288
    v_add_f32 v255, v230, v231
    v_mfma_f32_16x16x32_bf16 v[64:67], a[108:111], v[28:31], v[64:67]
    ds_read_b128 a[152:155], v162 offset:12288
    v_add_f32 v248, v248, v249
    v_mfma_f32_16x16x32_bf16 v[68:71], a[112:115], v[16:19], v[136:139]
    v_add_f32 v250, v250, v251
    v_add_f32 v252, v252, v253
    v_mfma_f32_16x16x32_bf16 v[68:71], a[116:119], v[20:23], v[68:71]
    ds_read_b128 a[156:159], v163 offset:12288
    v_add_f32 v254, v254, v255
    v_mfma_f32_16x16x32_bf16 v[68:71], a[120:123], v[24:27], v[68:71]
    v_add_f32 v248, v248, v250
    v_add_f32 v252, v252, v254
    v_mfma_f32_16x16x32_bf16 v[68:71], a[124:127], v[28:31], v[68:71]
    v_add_f32 v248, v248, v252
    s_waitcnt lgkmcnt(4)
    v_mfma_f32_16x16x32_bf16 v[72:75], a[128:131], v[16:19], v[136:139]
    v_cmp_gt_f32 vcc, v248, v150
    s_cbranch_vccnz A_SLOW_2
A_BACK_2:
    v_mfma_f32_16x16x32_bf16 v[72:75], a[132:135], v[20:23], v[72:75]
    v_add_f32 v153, v153, v248
    v_mfma_f32_16x16x32_bf16 v[72:75], a[136:139], v[24:27], v[72:75]
    v_cvt_pk_bf16_f32 v128, v216, v217
    v_cvt_pk_bf16_f32 v129, v218, v219
    v_mfma_f32_16x16x32_bf16 v[72:75], a[140:143], v[28:31], v[72:75]
    v_cvt_pk_bf16_f32 v130, v220, v221
    s_waitcnt lgkmcnt(3)
    v_mfma_f32_16x16x32_bf16 v[76:79], a[144:147], v[16:19], v[136:139]
    v_cvt_pk_bf16_f32 v131, v222, v223
    s_waitcnt lgkmcnt(2)
    v_mfma_f32_16x16x32_bf16 v[76:79], a[148:151], v[20:23], v[76:79]
    v_cvt_pk_bf16_f32 v132, v224, v225
    v_cvt_pk_bf16_f32 v133, v226, v227
    s_waitcnt lgkmcnt(1)
    v_mfma_f32_16x16x32_bf16 v[76:79], a[152:155], v[24:27], v[76:79]
    v_cvt_pk_bf16_f32 v134, v228, v229
    s_waitcnt lgkmcnt(0)
    v_mfma_f32_16x16x32_bf16 v[76:79], a[156:159], v[28:31], v[76:79]
    v_cvt_pk_bf16_f32 v135, v230, v231
    s_cmp_eq_u32 s18, 0
    s_cbranch_scc1 A_FIX
A_FIXBACK:
    s_nop 1
    v_mfma_f32_16x16x32_bf16 a[64:67], a[160:163], v[128:131], a[64:67]
    v_add_u32 v164, s17, v176
    v_add_u32 v165, s17, v177
    v_mfma_f32_16x16x32_bf16 a[68:71], a[168:171], v[128:131], a[68:71]
    v_add_u32 v166, s17, v178
    v_add_u32 v167, s17, v179
    v_mfma_f32_16x16x32_bf16 a[72:75], a[176:179], v[128:131], a[72:75]
    v_add_u32 v168, s17, v180
    v_add_u32 v169, s17, v181
    v_exp_f32 v184, v64
    v_mfma_f32_16x16x32_bf16 a[76:79], a[184:187], v[128:131], a[76:79]
    v_add_u32 v170, s17, v182
    v_add_u32 v171, s17, v183
    v_exp_f32 v185, v65
    v_exp_f32 v186, v66
    v_mfma_f32_16x16x32_bf16 a[80:83], a[192:195], v[128:131], a[80:83]
    v_exp_f32 v187, v67
    v_mfma_f32_16x16x32_bf16 a[84:87], a[200:203], v[128:131], a[84:87]
    v_add_f32 v232, v184, v185
    v_exp_f32 v188, v68
    v_mfma_f32_16x16x32_bf16 a[88:91], a[208:211], v[128:131], a[88:91]
    v_exp_f32 v189, v69
    v_mfma_f32_16x16x32_bf16 a[92:95], a[216:219], v[128:131], a[92:95]
    v_add_f32 v233, v186, v187
    v_exp_f32 v190, v70
    v_mfma_f32_16x16x32_bf16 a[64:67], a[164:167], v[132:135], a[64:67]
    v_exp_f32 v191, v71
    ds_read_b64_tr_b16 a[160:161], v164 offset:0
    ds_read_b64_tr_b16 a[162:163], v164 offset:4096
    v_mfma_f32_16x16x32_bf16 a[68:71], a[172:175], v[132:135], a[68:71]
    v_add_f32 v234, v188, v189
    v_exp_f32 v192, v72
    ds_read_b64_tr_b16 a[168:169], v165 offset:0
    ds_read_b64_tr_b16 a[170:171], v165 offset:4096
    v_mfma_f32_16x16x32_bf16 a[72:75], a[180:183], v[132:135], a[72:75]
    v_exp_f32 v193, v73
    ds_read_b64_tr_b16 a[176:177], v166 offset:0
    ds_read_b64_tr_b16 a[178:179], v166 offset:4096
    v_mfma_f32_16x16x32_bf16 a[76:79], a[188:191], v[132:135], a[76:79]
    v_add_f32 v235, v190, v191
    v_exp_f32 v194, v74
    ds_read_b64_tr_b16 a[184:185], v167 offset:0
    ds_read_b64_tr_b16 a[186:187], v167 offset:4096
    v_mfma_f32_16x16x32_bf16 a[80:83], a[196:199], v[132:135], a[80:83]
    v_exp_f32 v195, v75
    ds_read_b64_tr_b16 a[192:193], v168 offset:0
    ds_read_b64_tr_b16 a[194:195], v168 offset:4096
    v_mfma_f32_16x16x32_bf16 a[84:87], a[204:207], v[132:135], a[84:87]
    v_exp_f32 v196, v76
    ds_read_b64_tr_b16 a[200:201], v169 offset:0
    ds_read_b64_tr_b16 a[202:203], v169 offset:4096
    v_mfma_f32_16x16x32_bf16 a[88:91], a[212:215], v[132:135], a[88:91]
    v_exp_f32 v197, v77
    v_exp_f32 v198, v78
    ds_read_b64_tr_b16 a[208:209], v170 offset:0
    ds_read_b64_tr_b16 a[210:211], v170 offset:4096
    v_mfma_f32_16x16x32_bf16 a[92:95], a[220:223], v[132:135], a[92:95]
    v_exp_f32 v199, v79
    ds_read_b64_tr_b16 a[216:217], v171 offset:0
    ds_read_b64_tr_b16 a[218:219], v171 offset:4096
    v_mfma_f32_16x16x32_bf16 v[80:83], a[96:99], v[32:35], v[140:143]
    v_add_f32 v236, v192, v193
    ds_read_b64_tr_b16 a[164:165], v164 offset:8192
    v_mfma_f32_16x16x32_bf16 v[80:83], a[100:103], v[36:39], v[80:83]
    v_add_f32 v237, v194, v195
    v_add_f32 v238, v196, v197
    ds_read_b64_tr_b16 a[166:167], v164 offset:12288
    ds_read_b64_tr_b16 a[172:173], v165 offset:8192
    v_mfma_f32_16x16x32_bf16 v[80:83], a[104:107], v[40:43], v[80:83]
    v_add_f32 v239, v198, v199
    ds_read_b64_tr_b16 a[174:175], v165 offset:12288
    v_mfma_f32_16x16x32_bf16 v[80:83], a[108:111], v[44:47], v[80:83]
    v_add_f32 v232, v232, v233
    ds_read_b64_tr_b16 a[180:181], v166 offset:8192
    v_mfma_f32_16x16x32_bf16 v[84:87], a[112:115], v[32:35], v[140:143]
    v_add_f32 v234, v234, v235
    v_add_f32 v236, v236, v237
    ds_read_b64_tr_b16 a[182:183], v166 offset:12288
    ds_read_b64_tr_b16 a[188:189], v167 offset:8192
    v_mfma_f32_16x16x32_bf16 v[84:87], a[116:119], v[36:39], v[84:87]
    v_add_f32 v238, v238, v239
    ds_read_b64_tr_b16 a[190:191], v167 offset:12288
    v_mfma_f32_16x16x32_bf16 v[84:87], a[120:123], v[40:43], v[84:87]
    v_add_f32 v232, v232, v234
    ds_read_b64_tr_b16 a[196:197], v168 offset:8192
    v_mfma_f32_16x16x32_bf16 v[84:87], a[124:127], v[44:47], v[84:87]
    v_add_f32 v236, v236, v238
    v_add_f32 v232, v232, v236
    ds_read_b64_tr_b16 a[198:199], v168 offset:12288
    ds_read_b64_tr_b16 a[204:205], v169 offset:8192
    v_mfma_f32_16x16x32_bf16 v[88:91], a[128:131], v[32:35], v[140:143]
    v_cmp_gt_f32 vcc, v232, v148
    ds_read_b64_tr_b16 a[206:207], v169 offset:12288
    v_mfma_f32_16x16x32_bf16 v[88:91], a[132:135], v[36:39], v[88:91]
    s_cbranch_vccnz A_SLOW_0
A_BACK_0:
    v_add_f32 v151, v151, v232
    ds_read_b64_tr_b16 a[212:213], v170 offset:8192
    v_mfma_f32_16x16x32_bf16 v[88:91], a[136:139], v[40:43], v[88:91]
    v_cvt_pk_bf16_f32 v112, v184, v185
    ds_read_b64_tr_b16 a[214:215], v170 offset:12288
    ds_read_b64_tr_b16 a[220:221], v171 offset:8192
    v_mfma_f32_16x16x32_bf16 v[88:91], a[140:143], v[44:47], v[88:91]
    v_cvt_pk_bf16_f32 v113, v186, v187
    v_cvt_pk_bf16_f32 v114, v188, v189
    ds_read_b64_tr_b16 a[222:223], v171 offset:12288
    v_mfma_f32_16x16x32_bf16 v[92:95], a[144:147], v[32:35], v[140:143]
    v_cvt_pk_bf16_f32 v115, v190, v191
    v_mfma_f32_16x16x32_bf16 v[92:95], a[148:151], v[36:39], v[92:95]
    v_cvt_pk_bf16_f32 v116, v192, v193
    v_mfma_f32_16x16x32_bf16 v[92:95], a[152:155], v[40:43], v[92:95]
    v_cvt_pk_bf16_f32 v117, v194, v195
    v_cvt_pk_bf16_f32 v118, v196, v197
    v_mfma_f32_16x16x32_bf16 v[92:95], a[156:159], v[44:47], v[92:95]
    v_cvt_pk_bf16_f32 v119, v198, v199
    s_add_u32 s17, s17, 32768
    s_cmp_eq_u32 s17, 163840
    s_cselect_b32 s17, 0, s17
    s_waitcnt lgkmcnt(14)
    v_mfma_f32_16x16x32_bf16 a[0:3], a[160:163], v[112:115], a[0:3]
    v_add_u32 v160, s17, v172
    v_add_u32 v161, s17, v173
    v_mfma_f32_16x16x32_bf16 a[4:7], a[168:171], v[112:115], a[4:7]
    v_add_u32 v162, s17, v174
    v_add_u32 v163, s17, v175
    v_exp_f32 v200, v80
    v_mfma_f32_16x16x32_bf16 a[8:11], a[176:179], v[112:115], a[8:11]
    v_exp_f32 v201, v81
    v_mfma_f32_16x16x32_bf16 a[12:15], a[184:187], v[112:115], a[12:15]
    v_exp_f32 v202, v82
    v_exp_f32 v203, v83
    v_mfma_f32_16x16x32_bf16 a[16:19], a[192:195], v[112:115], a[16:19]
    v_add_f32 v240, v200, v201
    v_mfma_f32_16x16x32_bf16 a[20:23], a[200:203], v[112:115], a[20:23]
    v_exp_f32 v204, v84
    v_mfma_f32_16x16x32_bf16 a[24:27], a[208:211], v[112:115], a[24:27]
    v_exp_f32 v205, v85
    v_add_f32 v241, v202, v203
    v_mfma_f32_16x16x32_bf16 a[28:31], a[216:219], v[112:115], a[28:31]
    v_exp_f32 v206, v86
    v_mfma_f32_16x16x32_bf16 a[0:3], a[164:167], v[116:119], a[0:3]
    v_exp_f32 v207, v87
    v_add_f32 v242, v204, v205
    s_waitcnt lgkmcnt(4)
    v_mfma_f32_16x16x32_bf16 a[4:7], a[172:175], v[116:119], a[4:7]
    v_exp_f32 v208, v88
    v_mfma_f32_16x16x32_bf16 a[8:11], a[180:183], v[116:119], a[8:11]
    v_exp_f32 v209, v89
    v_add_f32 v243, v206, v207
    v_mfma_f32_16x16x32_bf16 a[12:15], a[188:191], v[116:119], a[12:15]
    v_exp_f32 v210, v90
    v_mfma_f32_16x16x32_bf16 a[16:19], a[196:199], v[116:119], a[16:19]
    v_exp_f32 v211, v91
    v_mfma_f32_16x16x32_bf16 a[20:23], a[204:207], v[116:119], a[20:23]
    v_exp_f32 v212, v92
    v_exp_f32 v213, v93
    s_waitcnt lgkmcnt(2)
    v_mfma_f32_16x16x32_bf16 a[24:27], a[212:215], v[116:119], a[24:27]
    v_exp_f32 v214, v94
    s_waitcnt lgkmcnt(0)
    v_mfma_f32_16x16x32_bf16 a[28:31], a[220:223], v[116:119], a[28:31]
    v_exp_f32 v215, v95
    s_barrier
    v_mfma_f32_16x16x32_bf16 v[96:99], a[96:99], v[48:51], v[144:147]
    v_add_f32 v244, v208, v209
    v_mfma_f32_16x16x32_bf16 v[96:99], a[100:103], v[52:55], v[96:99]
    v_add_f32 v245, v210, v211
    v_add_f32 v246, v212, v213
    v_mfma_f32_16x16x32_bf16 v[96:99], a[104:107], v[56:59], v[96:99]
    v_add_f32 v247, v214, v215
    v_mfma_f32_16x16x32_bf16 v[96:99], a[108:111], v[60:63], v[96:99]
    v_add_f32 v240, v240, v241
    v_mfma_f32_16x16x32_bf16 v[100:103], a[112:115], v[48:51], v[144:147]
    v_add_f32 v242, v242, v243
    v_add_f32 v244, v244, v245
    ds_read_b128 a[96:99], v160 offset:0
    v_mfma_f32_16x16x32_bf16 v[100:103], a[116:119], v[52:55], v[100:103]
    v_add_f32 v246, v246, v247
    ds_read_b128 a[100:103], v161 offset:0
    v_mfma_f32_16x16x32_bf16 v[100:103], a[120:123], v[56:59], v[100:103]
    v_add_f32 v240, v240, v242
    ds_read_b128 a[104:107], v162 offset:0
    v_mfma_f32_16x16x32_bf16 v[100:103], a[124:127], v[60:63], v[100:103]
    v_add_f32 v244, v244, v246
    v_add_f32 v240, v240, v244
    ds_read_b128 a[108:111], v163 offset:0
    v_mfma_f32_16x16x32_bf16 v[104:107], a[128:131], v[48:51], v[144:147]
    v_cmp_gt_f32 vcc, v240, v149
    ds_read_b128 a[112:115], v160 offset:4096
    v_mfma_f32_16x16x32_bf16 v[104:107], a[132:135], v[52:55], v[104:107]
    s_cbranch_vccnz A_SLOW_1
A_BACK_1:
    v_add_f32 v152, v152, v240
    ds_read_b128 a[116:119], v161 offset:4096
    v_mfma_f32_16x16x32_bf16 v[104:107], a[136:139], v[56:59], v[104:107]
    v_cvt_pk_bf16_f32 v120, v200, v201
    ds_read_b128 a[120:123], v162 offset:4096
    v_mfma_f32_16x16x32_bf16 v[104:107], a[140:143], v[60:63], v[104:107]
    v_cvt_pk_bf16_f32 v121, v202, v203
    v_cvt_pk_bf16_f32 v122, v204, v205
    ds_read_b128 a[124:127], v163 offset:4096
    v_mfma_f32_16x16x32_bf16 v[108:111], a[144:147], v[48:51], v[144:147]
    v_cvt_pk_bf16_f32 v123, v206, v207
    v_mfma_f32_16x16x32_bf16 v[108:111], a[148:151], v[52:55], v[108:111]
    v_cvt_pk_bf16_f32 v124, v208, v209
    v_mfma_f32_16x16x32_bf16 v[108:111], a[152:155], v[56:59], v[108:111]
    v_cvt_pk_bf16_f32 v125, v210, v211
    v_cvt_pk_bf16_f32 v126, v212, v213
    v_mfma_f32_16x16x32_bf16 v[108:111], a[156:159], v[60:63], v[108:111]
    v_cvt_pk_bf16_f32 v127, v214, v215
    s_nop 1
    v_mfma_f32_16x16x32_bf16 a[32:35], a[160:163], v[120:123], a[32:35]
    v_mfma_f32_16x16x32_bf16 a[36:39], a[168:171], v[120:123], a[36:39]
    ds_read_b128 a[128:131], v160 offset:8192
    v_mfma_f32_16x16x32_bf16 a[40:43], a[176:179], v[120:123], a[40:43]
    v_exp_f32 v216, v96
    v_mfma_f32_16x16x32_bf16 a[44:47], a[184:187], v[120:123], a[44:47]
    v_exp_f32 v217, v97
    v_exp_f32 v218, v98
    ds_read_b128 a[132:135], v161 offset:8192
    v_mfma_f32_16x16x32_bf16 a[48:51], a[192:195], v[120:123], a[48:51]
    v_exp_f32 v219, v99
    v_mfma_f32_16x16x32_bf16 a[52:55], a[200:203], v[120:123], a[52:55]
    v_add_f32 v248, v216, v217
    v_exp_f32 v220, v100
    ds_read_b128 a[136:139], v162 offset:8192
    v_mfma_f32_16x16x32_bf16 a[56:59], a[208:211], v[120:123], a[56:59]
    v_exp_f32 v221, v101
    v_mfma_f32_16x16x32_bf16 a[60:63], a[216:219], v[120:123], a[60:63]
    v_add_f32 v249, v218, v219
    v_exp_f32 v222, v102
    ds_read_b128 a[140:143], v163 offset:8192
    v_mfma_f32_16x16x32_bf16 a[32:35], a[164:167], v[124:127], a[32:35]
    v_exp_f32 v223, v103
    v_mfma_f32_16x16x32_bf16 a[36:39], a[172:175], v[124:127], a[36:39]
    v_add_f32 v250, v220, v221
    v_exp_f32 v224, v104
    v_mfma_f32_16x16x32_bf16 a[40:43], a[180:183], v[124:127], a[40:43]
    v_exp_f32 v225, v105
    v_mfma_f32_16x16x32_bf16 a[44:47], a[188:191], v[124:127], a[44:47]
    v_add_f32 v251, v222, v223
    v_exp_f32 v226, v106
    v_mfma_f32_16x16x32_bf16 a[48:51], a[196:199], v[124:127], a[48:51]
    v_exp_f32 v227, v107
    v_mfma_f32_16x16x32_bf16 a[52:55], a[204:207], v[124:127], a[52:55]
    v_exp_f32 v228, v108
    v_mfma_f32_16x16x32_bf16 a[56:59], a[212:215], v[124:127], a[56:59]
    v_exp_f32 v229, v109
    v_exp_f32 v230, v110
    v_mfma_f32_16x16x32_bf16 a[60:63], a[220:223], v[124:127], a[60:63]
    v_exp_f32 v231, v111
    s_add_u32 s18, s18, 1
    s_cmp_lt_u32 s18, 16
    s_cbranch_scc1 A_LOOP
    s_nop 1
    v_add_f32 v252, v224, v225
    v_add_f32 v253, v226, v227
    v_add_f32 v254, v228, v229
    v_add_f32 v255, v230, v231
    v_add_f32 v248, v248, v249
    v_add_f32 v250, v250, v251
    v_add_f32 v252, v252, v253
    v_add_f32 v254, v254, v255
    v_add_f32 v248, v248, v250
    v_add_f32 v252, v252, v254
    v_add_f32 v248, v248, v252
    v_cmp_gt_f32 vcc, v248, v150
    s_cbranch_vccnz A_SLOW_2T
A_BACK_2T:
    v_add_f32 v153, v153, v248
    v_cvt_pk_bf16_f32 v128, v216, v217
    v_cvt_pk_bf16_f32 v129, v218, v219
    v_cvt_pk_bf16_f32 v130, v220, v221
    v_cvt_pk_bf16_f32 v131, v222, v223
    v_cvt_pk_bf16_f32 v132, v224, v225
    v_cvt_pk_bf16_f32 v133, v226, v227
    v_cvt_pk_bf16_f32 v134, v228, v229
    v_cvt_pk_bf16_f32 v135, v230, v231
    s_nop 1
    v_mfma_f32_16x16x32_bf16 a[64:67], a[160:163], v[128:131], a[64:67]
    v_mfma_f32_16x16x32_bf16 a[68:71], a[168:171], v[128:131], a[68:71]
    v_mfma_f32_16x16x32_bf16 a[72:75], a[176:179], v[128:131], a[72:75]
    v_mfma_f32_16x16x32_bf16 a[76:79], a[184:187], v[128:131], a[76:79]
    v_mfma_f32_16x16x32_bf16 a[80:83], a[192:195], v[128:131], a[80:83]
    v_mfma_f32_16x16x32_bf16 a[84:87], a[200:203], v[128:131], a[84:87]
    v_mfma_f32_16x16x32_bf16 a[88:91], a[208:211], v[128:131], a[88:91]
    v_mfma_f32_16x16x32_bf16 a[92:95], a[216:219], v[128:131], a[92:95]
    v_mfma_f32_16x16x32_bf16 a[64:67], a[164:167], v[132:135], a[64:67]
    v_mfma_f32_16x16x32_bf16 a[68:71], a[172:175], v[132:135], a[68:71]
    v_mfma_f32_16x16x32_bf16 a[72:75], a[180:183], v[132:135], a[72:75]
    v_mfma_f32_16x16x32_bf16 a[76:79], a[188:191], v[132:135], a[76:79]
    v_mfma_f32_16x16x32_bf16 a[80:83], a[196:199], v[132:135], a[80:83]
    v_mfma_f32_16x16x32_bf16 a[84:87], a[204:207], v[132:135], a[84:87]
    v_mfma_f32_16x16x32_bf16 a[88:91], a[212:215], v[132:135], a[88:91]
    v_mfma_f32_16x16x32_bf16 a[92:95], a[220:223], v[132:135], a[92:95]
    s_waitcnt lgkmcnt(0)
    s_nop 15
    s_mul_i32 s17, s16, 393216
    v_lshrrev_b32 v5, 1, v1
    v_lshlrev_b32 v5, 8, v5
    v_lshl_add_u32 v5, v2, 4, v5
    v_and_b32 v6, 1, v1
    v_lshl_add_u32 v5, v6, 3, v5
    v_add_u32 v5, s17, v5
    s_mov_b32 s42, 0
    s_mov_b32 s43, 131072
    s_mov_b32 s44, 262144
    v_mov_b32 v232, v151
    v_mov_b32 v233, v151
    s_nop 1
    v_permlane32_swap_b32 v232, v233
    v_add_f32 v232, v232, v233
    v_mov_b32 v233, v232
    s_nop 1
    v_permlane16_swap_b32 v232, v233
    v_add_f32 v232, v232, v233
    v_rcp_f32 v232, v232
    s_nop 0
    v_accvgpr_read_b32 v234, a0
    v_accvgpr_read_b32 v235, a1
    v_accvgpr_read_b32 v236, a2
    v_accvgpr_read_b32 v237, a3
    v_mul_f32 v234, v234, v232
    v_mul_f32 v235, v235, v232
    v_mul_f32 v236, v236, v232
    v_mul_f32 v237, v237, v232
    v_cvt_pk_bf16_f32 v64, v234, v235
    v_cvt_pk_bf16_f32 v65, v236, v237
    buffer_store_dwordx2 v[64:65], v5, s[36:39], s42 offen offset:0
    v_accvgpr_read_b32 v234, a4
    v_accvgpr_read_b32 v235, a5
    v_accvgpr_read_b32 v236, a6
    v_accvgpr_read_b32 v237, a7
    v_mul_f32 v234, v234, v232
    v_mul_f32 v235, v235, v232
    v_mul_f32 v236, v236, v232
    v_mul_f32 v237, v237, v232
    v_cvt_pk_bf16_f32 v66, v234, v235
    v_cvt_pk_bf16_f32 v67, v236, v237
    buffer_store_dwordx2 v[66:67], v5, s[36:39], s42 offen offset:512
    v_accvgpr_read_b32 v234, a8
    v_accvgpr_read_b32 v235, a9
    v_accvgpr_read_b32 v236, a10
    v_accvgpr_read_b32 v237, a11
    v_mul_f32 v234, v234, v232
    v_mul_f32 v235, v235, v232
    v_mul_f32 v236, v236, v232
    v_mul_f32 v237, v237, v232
    v_cvt_pk_bf16_f32 v68, v234, v235
    v_cvt_pk_bf16_f32 v69, v236, v237
    buffer_store_dwordx2 v[68:69], v5, s[36:39], s42 offen offset:1024
    v_accvgpr_read_b32 v234, a12
    v_accvgpr_read_b32 v235, a13
    v_accvgpr_read_b32 v236, a14
    v_accvgpr_read_b32 v237, a15
    v_mul_f32 v234, v234, v232
    v_mul_f32 v235, v235, v232
    v_mul_f32 v236, v236, v232
    v_mul_f32 v237, v237, v232
    v_cvt_pk_bf16_f32 v70, v234, v235
    v_cvt_pk_bf16_f32 v71, v236, v237
    buffer_store_dwordx2 v[70:71], v5, s[36:39], s42 offen offset:1536
    v_accvgpr_read_b32 v234, a16
    v_accvgpr_read_b32 v235, a17
    v_accvgpr_read_b32 v236, a18
    v_accvgpr_read_b32 v237, a19
    v_mul_f32 v234, v234, v232
    v_mul_f32 v235, v235, v232
    v_mul_f32 v236, v236, v232
    v_mul_f32 v237, v237, v232
    v_cvt_pk_bf16_f32 v72, v234, v235
    v_cvt_pk_bf16_f32 v73, v236, v237
    buffer_store_dwordx2 v[72:73], v5, s[36:39], s42 offen offset:2048
    v_accvgpr_read_b32 v234, a20
    v_accvgpr_read_b32 v235, a21
    v_accvgpr_read_b32 v236, a22
    v_accvgpr_read_b32 v237, a23
    v_mul_f32 v234, v234, v232
    v_mul_f32 v235, v235, v232
    v_mul_f32 v236, v236, v232
    v_mul_f32 v237, v237, v232
    v_cvt_pk_bf16_f32 v74, v234, v235
    v_cvt_pk_bf16_f32 v75, v236, v237
    buffer_store_dwordx2 v[74:75], v5, s[36:39], s42 offen offset:2560
    v_accvgpr_read_b32 v234, a24
    v_accvgpr_read_b32 v235, a25
    v_accvgpr_read_b32 v236, a26
    v_accvgpr_read_b32 v237, a27
    v_mul_f32 v234, v234, v232
    v_mul_f32 v235, v235, v232
    v_mul_f32 v236, v236, v232
    v_mul_f32 v237, v237, v232
    v_cvt_pk_bf16_f32 v76, v234, v235
    v_cvt_pk_bf16_f32 v77, v236, v237
    buffer_store_dwordx2 v[76:77], v5, s[36:39], s42 offen offset:3072
    v_accvgpr_read_b32 v234, a28
    v_accvgpr_read_b32 v235, a29
    v_accvgpr_read_b32 v236, a30
    v_accvgpr_read_b32 v237, a31
    v_mul_f32 v234, v234, v232
    v_mul_f32 v235, v235, v232
    v_mul_f32 v236, v236, v232
    v_mul_f32 v237, v237, v232
    v_cvt_pk_bf16_f32 v78, v234, v235
    v_cvt_pk_bf16_f32 v79, v236, v237
    buffer_store_dwordx2 v[78:79], v5, s[36:39], s42 offen offset:3584
    v_mov_b32 v232, v152
    v_mov_b32 v233, v152
    s_nop 1
    v_permlane32_swap_b32 v232, v233
    v_add_f32 v232, v232, v233
    v_mov_b32 v233, v232
    s_nop 1
    v_permlane16_swap_b32 v232, v233
    v_add_f32 v232, v232, v233
    v_rcp_f32 v232, v232
    s_nop 0
    v_accvgpr_read_b32 v234, a32
    v_accvgpr_read_b32 v235, a33
    v_accvgpr_read_b32 v236, a34
    v_accvgpr_read_b32 v237, a35
    v_mul_f32 v234, v234, v232
    v_mul_f32 v235, v235, v232
    v_mul_f32 v236, v236, v232
    v_mul_f32 v237, v237, v232
    v_cvt_pk_bf16_f32 v80, v234, v235
    v_cvt_pk_bf16_f32 v81, v236, v237
    buffer_store_dwordx2 v[80:81], v5, s[36:39], s43 offen offset:0
    v_accvgpr_read_b32 v234, a36
    v_accvgpr_read_b32 v235, a37
    v_accvgpr_read_b32 v236, a38
    v_accvgpr_read_b32 v237, a39
    v_mul_f32 v234, v234, v232
    v_mul_f32 v235, v235, v232
    v_mul_f32 v236, v236, v232
    v_mul_f32 v237, v237, v232
    v_cvt_pk_bf16_f32 v82, v234, v235
    v_cvt_pk_bf16_f32 v83, v236, v237
    buffer_store_dwordx2 v[82:83], v5, s[36:39], s43 offen offset:512
    v_accvgpr_read_b32 v234, a40
    v_accvgpr_read_b32 v235, a41
    v_accvgpr_read_b32 v236, a42
    v_accvgpr_read_b32 v237, a43
    v_mul_f32 v234, v234, v232
    v_mul_f32 v235, v235, v232
    v_mul_f32 v236, v236, v232
    v_mul_f32 v237, v237, v232
    v_cvt_pk_bf16_f32 v84, v234, v235
    v_cvt_pk_bf16_f32 v85, v236, v237
    buffer_store_dwordx2 v[84:85], v5, s[36:39], s43 offen offset:1024
    v_accvgpr_read_b32 v234, a44
    v_accvgpr_read_b32 v235, a45
    v_accvgpr_read_b32 v236, a46
    v_accvgpr_read_b32 v237, a47
    v_mul_f32 v234, v234, v232
    v_mul_f32 v235, v235, v232
    v_mul_f32 v236, v236, v232
    v_mul_f32 v237, v237, v232
    v_cvt_pk_bf16_f32 v86, v234, v235
    v_cvt_pk_bf16_f32 v87, v236, v237
    buffer_store_dwordx2 v[86:87], v5, s[36:39], s43 offen offset:1536
    v_accvgpr_read_b32 v234, a48
    v_accvgpr_read_b32 v235, a49
    v_accvgpr_read_b32 v236, a50
    v_accvgpr_read_b32 v237, a51
    v_mul_f32 v234, v234, v232
    v_mul_f32 v235, v235, v232
    v_mul_f32 v236, v236, v232
    v_mul_f32 v237, v237, v232
    v_cvt_pk_bf16_f32 v88, v234, v235
    v_cvt_pk_bf16_f32 v89, v236, v237
    buffer_store_dwordx2 v[88:89], v5, s[36:39], s43 offen offset:2048
    v_accvgpr_read_b32 v234, a52
    v_accvgpr_read_b32 v235, a53
    v_accvgpr_read_b32 v236, a54
    v_accvgpr_read_b32 v237, a55
    v_mul_f32 v234, v234, v232
    v_mul_f32 v235, v235, v232
    v_mul_f32 v236, v236, v232
    v_mul_f32 v237, v237, v232
    v_cvt_pk_bf16_f32 v90, v234, v235
    v_cvt_pk_bf16_f32 v91, v236, v237
    buffer_store_dwordx2 v[90:91], v5, s[36:39], s43 offen offset:2560
    v_accvgpr_read_b32 v234, a56
    v_accvgpr_read_b32 v235, a57
    v_accvgpr_read_b32 v236, a58
    v_accvgpr_read_b32 v237, a59
    v_mul_f32 v234, v234, v232
    v_mul_f32 v235, v235, v232
    v_mul_f32 v236, v236, v232
    v_mul_f32 v237, v237, v232
    v_cvt_pk_bf16_f32 v92, v234, v235
    v_cvt_pk_bf16_f32 v93, v236, v237
    buffer_store_dwordx2 v[92:93], v5, s[36:39], s43 offen offset:3072
    v_accvgpr_read_b32 v234, a60
    v_accvgpr_read_b32 v235, a61
    v_accvgpr_read_b32 v236, a62
    v_accvgpr_read_b32 v237, a63
    v_mul_f32 v234, v234, v232
    v_mul_f32 v235, v235, v232
    v_mul_f32 v236, v236, v232
    v_mul_f32 v237, v237, v232
    v_cvt_pk_bf16_f32 v94, v234, v235
    v_cvt_pk_bf16_f32 v95, v236, v237
    buffer_store_dwordx2 v[94:95], v5, s[36:39], s43 offen offset:3584
    v_mov_b32 v232, v153
    v_mov_b32 v233, v153
    s_nop 1
    v_permlane32_swap_b32 v232, v233
    v_add_f32 v232, v232, v233
    v_mov_b32 v233, v232
    s_nop 1
    v_permlane16_swap_b32 v232, v233
    v_add_f32 v232, v232, v233
    v_rcp_f32 v232, v232
    s_nop 0
    v_accvgpr_read_b32 v234, a64
    v_accvgpr_read_b32 v235, a65
    v_accvgpr_read_b32 v236, a66
    v_accvgpr_read_b32 v237, a67
    v_mul_f32 v234, v234, v232
    v_mul_f32 v235, v235, v232
    v_mul_f32 v236, v236, v232
    v_mul_f32 v237, v237, v232
    v_cvt_pk_bf16_f32 v96, v234, v235
    v_cvt_pk_bf16_f32 v97, v236, v237
    buffer_store_dwordx2 v[96:97], v5, s[36:39], s44 offen offset:0
    v_accvgpr_read_b32 v234, a68
    v_accvgpr_read_b32 v235, a69
    v_accvgpr_read_b32 v236, a70
    v_accvgpr_read_b32 v237, a71
    v_mul_f32 v234, v234, v232
    v_mul_f32 v235, v235, v232
    v_mul_f32 v236, v236, v232
    v_mul_f32 v237, v237, v232
    v_cvt_pk_bf16_f32 v98, v234, v235
    v_cvt_pk_bf16_f32 v99, v236, v237
    buffer_store_dwordx2 v[98:99], v5, s[36:39], s44 offen offset:512
    v_accvgpr_read_b32 v234, a72
    v_accvgpr_read_b32 v235, a73
    v_accvgpr_read_b32 v236, a74
    v_accvgpr_read_b32 v237, a75
    v_mul_f32 v234, v234, v232
    v_mul_f32 v235, v235, v232
    v_mul_f32 v236, v236, v232
    v_mul_f32 v237, v237, v232
    v_cvt_pk_bf16_f32 v100, v234, v235
    v_cvt_pk_bf16_f32 v101, v236, v237
    buffer_store_dwordx2 v[100:101], v5, s[36:39], s44 offen offset:1024
    v_accvgpr_read_b32 v234, a76
    v_accvgpr_read_b32 v235, a77
    v_accvgpr_read_b32 v236, a78
    v_accvgpr_read_b32 v237, a79
    v_mul_f32 v234, v234, v232
    v_mul_f32 v235, v235, v232
    v_mul_f32 v236, v236, v232
    v_mul_f32 v237, v237, v232
    v_cvt_pk_bf16_f32 v102, v234, v235
    v_cvt_pk_bf16_f32 v103, v236, v237
    buffer_store_dwordx2 v[102:103], v5, s[36:39], s44 offen offset:1536
    v_accvgpr_read_b32 v234, a80
    v_accvgpr_read_b32 v235, a81
    v_accvgpr_read_b32 v236, a82
    v_accvgpr_read_b32 v237, a83
    v_mul_f32 v234, v234, v232
    v_mul_f32 v235, v235, v232
    v_mul_f32 v236, v236, v232
    v_mul_f32 v237, v237, v232
    v_cvt_pk_bf16_f32 v104, v234, v235
    v_cvt_pk_bf16_f32 v105, v236, v237
    buffer_store_dwordx2 v[104:105], v5, s[36:39], s44 offen offset:2048
    v_accvgpr_read_b32 v234, a84
    v_accvgpr_read_b32 v235, a85
    v_accvgpr_read_b32 v236, a86
    v_accvgpr_read_b32 v237, a87
    v_mul_f32 v234, v234, v232
    v_mul_f32 v235, v235, v232
    v_mul_f32 v236, v236, v232
    v_mul_f32 v237, v237, v232
    v_cvt_pk_bf16_f32 v106, v234, v235
    v_cvt_pk_bf16_f32 v107, v236, v237
    buffer_store_dwordx2 v[106:107], v5, s[36:39], s44 offen offset:2560
    v_accvgpr_read_b32 v234, a88
    v_accvgpr_read_b32 v235, a89
    v_accvgpr_read_b32 v236, a90
    v_accvgpr_read_b32 v237, a91
    v_mul_f32 v234, v234, v232
    v_mul_f32 v235, v235, v232
    v_mul_f32 v236, v236, v232
    v_mul_f32 v237, v237, v232
    v_cvt_pk_bf16_f32 v108, v234, v235
    v_cvt_pk_bf16_f32 v109, v236, v237
    buffer_store_dwordx2 v[108:109], v5, s[36:39], s44 offen offset:3072
    v_accvgpr_read_b32 v234, a92
    v_accvgpr_read_b32 v235, a93
    v_accvgpr_read_b32 v236, a94
    v_accvgpr_read_b32 v237, a95
    v_mul_f32 v234, v234, v232
    v_mul_f32 v235, v235, v232
    v_mul_f32 v236, v236, v232
    v_mul_f32 v237, v237, v232
    v_cvt_pk_bf16_f32 v110, v234, v235
    v_cvt_pk_bf16_f32 v111, v236, v237
    buffer_store_dwordx2 v[110:111], v5, s[36:39], s44 offen offset:3584
    s_branch A_END
A_FIX:
    v_mov_b32 v150, -1.0
    s_branch A_FIXBACK
A_SLOW_0:
    v_max3_f32 v232, v64, v65, v66
    v_max3_f32 v233, v67, v68, v69
    v_max3_f32 v234, v70, v71, v72
    v_max3_f32 v235, v73, v74, v75
    v_max3_f32 v232, v232, v233, v234
    v_max3_f32 v236, v76, v77, v78
    v_max3_f32 v232, v232, v235, v79
    v_max_f32 v232, v232, v236
    v_mov_b32 v233, v232
    s_nop 1
    v_permlane32_swap_b32 v232, v233
    v_max_f32 v232, v232, v233
    v_mov_b32 v233, v232
    s_nop 1
    v_permlane16_swap_b32 v232, v233
    v_max3_f32 v232, v232, v233, v154
    v_mov_b32 v154, 0
    v_mov_b32 v148, s50
    v_sub_f32 v233, 0, v232
    v_exp_f32 v233, v233
    v_sub_f32 v136, v136, v232
    v_sub_f32 v137, v137, v232
    v_sub_f32 v138, v138, v232
    v_sub_f32 v139, v139, v232
    v_min_f32 v233, v233, s50
    v_mul_f32 v151, v151, v233
    s_nop 7
    v_accvgpr_read_b32 v234, a0
    v_mul_f32 v234, v234, v233
    v_accvgpr_write_b32 a0, v234
    v_accvgpr_read_b32 v235, a1
    v_mul_f32 v235, v235, v233
    v_accvgpr_write_b32 a1, v235
    v_accvgpr_read_b32 v236, a2
    v_mul_f32 v236, v236, v233
    v_accvgpr_write_b32 a2, v236
    v_accvgpr_read_b32 v237, a3
    v_mul_f32 v237, v237, v233
    v_accvgpr_write_b32 a3, v237
    v_accvgpr_read_b32 v234, a4
    v_mul_f32 v234, v234, v233
    v_accvgpr_write_b32 a4, v234
    v_accvgpr_read_b32 v235, a5
    v_mul_f32 v235, v235, v233
    v_accvgpr_write_b32 a5, v235
    v_accvgpr_read_b32 v236, a6
    v_mul_f32 v236, v236, v233
    v_accvgpr_write_b32 a6, v236
    v_accvgpr_read_b32 v237, a7
    v_mul_f32 v237, v237, v233
    v_accvgpr_write_b32 a7, v237
    v_accvgpr_read_b32 v234, a8
    v_mul_f32 v234, v234, v233
    v_accvgpr_write_b32 a8, v234
    v_accvgpr_read_b32 v235, a9
    v_mul_f32 v235, v235, v233
    v_accvgpr_write_b32 a9, v235
    v_accvgpr_read_b32 v236, a10
    v_mul_f32 v236, v236, v233
    v_accvgpr_write_b32 a10, v236
    v_accvgpr_read_b32 v237, a11
    v_mul_f32 v237, v237, v233
    v_accvgpr_write_b32 a11, v237
    v_accvgpr_read_b32 v234, a12
    v_mul_f32 v234, v234, v233
    v_accvgpr_write_b32 a12, v234
    v_accvgpr_read_b32 v235, a13
    v_mul_f32 v235, v235, v233
    v_accvgpr_write_b32 a13, v235
    v_accvgpr_read_b32 v236, a14
    v_mul_f32 v236, v236, v233
    v_accvgpr_write_b32 a14, v236
    v_accvgpr_read_b32 v237, a15
    v_mul_f32 v237, v237, v233
    v_accvgpr_write_b32 a15, v237
    v_accvgpr_read_b32 v234, a16
    v_mul_f32 v234, v234, v233
    v_accvgpr_write_b32 a16, v234
    v_accvgpr_read_b32 v235, a17
    v_mul_f32 v235, v235, v233
    v_accvgpr_write_b32 a17, v235
    v_accvgpr_read_b32 v236, a18
    v_mul_f32 v236, v236, v233
    v_accvgpr_write_b32 a18, v236
    v_accvgpr_read_b32 v237, a19
    v_mul_f32 v237, v237, v233
    v_accvgpr_write_b32 a19, v237
    v_accvgpr_read_b32 v234, a20
    v_mul_f32 v234, v234, v233
    v_accvgpr_write_b32 a20, v234
    v_accvgpr_read_b32 v235, a21
    v_mul_f32 v235, v235, v233
    v_accvgpr_write_b32 a21, v235
    v_accvgpr_read_b32 v236, a22
    v_mul_f32 v236, v236, v233
    v_accvgpr_write_b32 a22, v236
    v_accvgpr_read_b32 v237, a23
    v_mul_f32 v237, v237, v233
    v_accvgpr_write_b32 a23, v237
    v_accvgpr_read_b32 v234, a24
    v_mul_f32 v234, v234, v233
    v_accvgpr_write_b32 a24, v234
    v_accvgpr_read_b32 v235, a25
    v_mul_f32 v235, v235, v233
    v_accvgpr_write_b32 a25, v235
    v_accvgpr_read_b32 v236, a26
    v_mul_f32 v236, v236, v233
    v_accvgpr_write_b32 a26, v236
    v_accvgpr_read_b32 v237, a27
    v_mul_f32 v237, v237, v233
    v_accvgpr_write_b32 a27, v237
    v_accvgpr_read_b32 v234, a28
    v_mul_f32 v234, v234, v233
    v_accvgpr_write_b32 a28, v234
    v_accvgpr_read_b32 v235, a29
    v_mul_f32 v235, v235, v233
    v_accvgpr_write_b32 a29, v235
    v_accvgpr_read_b32 v236, a30
    v_mul_f32 v236, v236, v233
    v_accvgpr_write_b32 a30, v236
    v_accvgpr_read_b32 v237, a31
    v_mul_f32 v237, v237, v233
    v_accvgpr_write_b32 a31, v237
    v_sub_f32 v184, v64, v232
    v_sub_f32 v185, v65, v232
    v_sub_f32 v186, v66, v232
    v_sub_f32 v187, v67, v232
    v_sub_f32 v188, v68, v232
    v_sub_f32 v189, v69, v232
    v_sub_f32 v190, v70, v232
    v_sub_f32 v191, v71, v232
    v_sub_f32 v192, v72, v232
    v_sub_f32 v193, v73, v232
    v_sub_f32 v194, v74, v232
    v_sub_f32 v195, v75, v232
    v_sub_f32 v196, v76, v232
    v_sub_f32 v197, v77, v232
    v_sub_f32 v198, v78, v232
    v_sub_f32 v199, v79, v232
    v_exp_f32 v184, v184
    v_exp_f32 v185, v185
    v_exp_f32 v186, v186
    v_exp_f32 v187, v187
    v_exp_f32 v188, v188
    v_exp_f32 v189, v189
    v_exp_f32 v190, v190
    v_exp_f32 v191, v191
    v_exp_f32 v192, v192
    v_exp_f32 v193, v193
    v_exp_f32 v194, v194
    v_exp_f32 v195, v195
    v_exp_f32 v196, v196
    v_exp_f32 v197, v197
    v_exp_f32 v198, v198
    v_exp_f32 v199, v199
    s_nop 0
    v_add_f32 v232, v184, v185
    v_add_f32 v232, v232, v186
    v_add_f32 v232, v232, v187
    v_add_f32 v232, v232, v188
    v_add_f32 v232, v232, v189
    v_add_f32 v232, v232, v190
    v_add_f32 v232, v232, v191
    v_add_f32 v232, v232, v192
    v_add_f32 v232, v232, v193
    v_add_f32 v232, v232, v194
    v_add_f32 v232, v232, v195
    v_add_f32 v232, v232, v196
    v_add_f32 v232, v232, v197
    v_add_f32 v232, v232, v198
    v_add_f32 v232, v232, v199
    s_branch A_BACK_0
A_SLOW_1:
    v_max3_f32 v240, v80, v81, v82
    v_max3_f32 v241, v83, v84, v85
    v_max3_f32 v242, v86, v87, v88
    v_max3_f32 v243, v89, v90, v91
    v_max3_f32 v240, v240, v241, v242
    v_max3_f32 v244, v92, v93, v94
    v_max3_f32 v240, v240, v243, v95
    v_max_f32 v240, v240, v244
    v_mov_b32 v241, v240
    s_nop 1
    v_permlane32_swap_b32 v240, v241
    v_max_f32 v240, v240, v241
    v_mov_b32 v241, v240
    s_nop 1
    v_permlane16_swap_b32 v240, v241
    v_max3_f32 v240, v240, v241, v155
    v_mov_b32 v155, 0
    v_mov_b32 v149, s50
    v_sub_f32 v241, 0, v240
    v_exp_f32 v241, v241
    v_sub_f32 v140, v140, v240
    v_sub_f32 v141, v141, v240
    v_sub_f32 v142, v142, v240
    v_sub_f32 v143, v143, v240
    v_min_f32 v241, v241, s50
    v_mul_f32 v152, v152, v241
    s_nop 7
    v_accvgpr_read_b32 v242, a32
    v_mul_f32 v242, v242, v241
    v_accvgpr_write_b32 a32, v242
    v_accvgpr_read_b32 v243, a33
    v_mul_f32 v243, v243, v241
    v_accvgpr_write_b32 a33, v243
    v_accvgpr_read_b32 v244, a34
    v_mul_f32 v244, v244, v241
    v_accvgpr_write_b32 a34, v244
    v_accvgpr_read_b32 v245, a35
    v_mul_f32 v245, v245, v241
    v_accvgpr_write_b32 a35, v245
    v_accvgpr_read_b32 v242, a36
    v_mul_f32 v242, v242, v241
    v_accvgpr_write_b32 a36, v242
    v_accvgpr_read_b32 v243, a37
    v_mul_f32 v243, v243, v241
    v_accvgpr_write_b32 a37, v243
    v_accvgpr_read_b32 v244, a38
    v_mul_f32 v244, v244, v241
    v_accvgpr_write_b32 a38, v244
    v_accvgpr_read_b32 v245, a39
    v_mul_f32 v245, v245, v241
    v_accvgpr_write_b32 a39, v245
    v_accvgpr_read_b32 v242, a40
    v_mul_f32 v242, v242, v241
    v_accvgpr_write_b32 a40, v242
    v_accvgpr_read_b32 v243, a41
    v_mul_f32 v243, v243, v241
    v_accvgpr_write_b32 a41, v243
    v_accvgpr_read_b32 v244, a42
    v_mul_f32 v244, v244, v241
    v_accvgpr_write_b32 a42, v244
    v_accvgpr_read_b32 v245, a43
    v_mul_f32 v245, v245, v241
    v_accvgpr_write_b32 a43, v245
    v_accvgpr_read_b32 v242, a44
    v_mul_f32 v242, v242, v241
    v_accvgpr_write_b32 a44, v242
    v_accvgpr_read_b32 v243, a45
    v_mul_f32 v243, v243, v241
    v_accvgpr_write_b32 a45, v243
    v_accvgpr_read_b32 v244, a46
    v_mul_f32 v244, v244, v241
    v_accvgpr_write_b32 a46, v244
    v_accvgpr_read_b32 v245, a47
    v_mul_f32 v245, v245, v241
    v_accvgpr_write_b32 a47, v245
    v_accvgpr_read_b32 v242, a48
    v_mul_f32 v242, v242, v241
    v_accvgpr_write_b32 a48, v242
    v_accvgpr_read_b32 v243, a49
    v_mul_f32 v243, v243, v241
    v_accvgpr_write_b32 a49, v243
    v_accvgpr_read_b32 v244, a50
    v_mul_f32 v244, v244, v241
    v_accvgpr_write_b32 a50, v244
    v_accvgpr_read_b32 v245, a51
    v_mul_f32 v245, v245, v241
    v_accvgpr_write_b32 a51, v245
    v_accvgpr_read_b32 v242, a52
    v_mul_f32 v242, v242, v241
    v_accvgpr_write_b32 a52, v242
    v_accvgpr_read_b32 v243, a53
    v_mul_f32 v243, v243, v241
    v_accvgpr_write_b32 a53, v243
    v_accvgpr_read_b32 v244, a54
    v_mul_f32 v244, v244, v241
    v_accvgpr_write_b32 a54, v244
    v_accvgpr_read_b32 v245, a55
    v_mul_f32 v245, v245, v241
    v_accvgpr_write_b32 a55, v245
    v_accvgpr_read_b32 v242, a56
    v_mul_f32 v242, v242, v241
    v_accvgpr_write_b32 a56, v242
    v_accvgpr_read_b32 v243, a57
    v_mul_f32 v243, v243, v241
    v_accvgpr_write_b32 a57, v243
    v_accvgpr_read_b32 v244, a58
    v_mul_f32 v244, v244, v241
    v_accvgpr_write_b32 a58, v244
    v_accvgpr_read_b32 v245, a59
    v_mul_f32 v245, v245, v241
    v_accvgpr_write_b32 a59, v245
    v_accvgpr_read_b32 v242, a60
    v_mul_f32 v242, v242, v241
    v_accvgpr_write_b32 a60, v242
    v_accvgpr_read_b32 v243, a61
    v_mul_f32 v243, v243, v241
    v_accvgpr_write_b32 a61, v243
    v_accvgpr_read_b32 v244, a62
    v_mul_f32 v244, v244, v241
    v_accvgpr_write_b32 a62, v244
    v_accvgpr_read_b32 v245, a63
    v_mul_f32 v245, v245, v241
    v_accvgpr_write_b32 a63, v245
    v_sub_f32 v200, v80, v240
    v_sub_f32 v201, v81, v240
    v_sub_f32 v202, v82, v240
    v_sub_f32 v203, v83, v240
    v_sub_f32 v204, v84, v240
    v_sub_f32 v205, v85, v240
    v_sub_f32 v206, v86, v240
    v_sub_f32 v207, v87, v240
    v_sub_f32 v208, v88, v240
    v_sub_f32 v209, v89, v240
    v_sub_f32 v210, v90, v240
    v_sub_f32 v211, v91, v240
    v_sub_f32 v212, v92, v240
    v_sub_f32 v213, v93, v240
    v_sub_f32 v214, v94, v240
    v_sub_f32 v215, v95, v240
    v_exp_f32 v200, v200
    v_exp_f32 v201, v201
    v_exp_f32 v202, v202
    v_exp_f32 v203, v203
    v_exp_f32 v204, v204
    v_exp_f32 v205, v205
    v_exp_f32 v206, v206
    v_exp_f32 v207, v207
    v_exp_f32 v208, v208
    v_exp_f32 v209, v209
    v_exp_f32 v210, v210
    v_exp_f32 v211, v211
    v_exp_f32 v212, v212
    v_exp_f32 v213, v213
    v_exp_f32 v214, v214
    v_exp_f32 v215, v215
    s_nop 0
    v_add_f32 v240, v200, v201
    v_add_f32 v240, v240, v202
    v_add_f32 v240, v240, v203
    v_add_f32 v240, v240, v204
    v_add_f32 v240, v240, v205
    v_add_f32 v240, v240, v206
    v_add_f32 v240, v240, v207
    v_add_f32 v240, v240, v208
    v_add_f32 v240, v240, v209
    v_add_f32 v240, v240, v210
    v_add_f32 v240, v240, v211
    v_add_f32 v240, v240, v212
    v_add_f32 v240, v240, v213
    v_add_f32 v240, v240, v214
    v_add_f32 v240, v240, v215
    s_branch A_BACK_1
A_SLOW_2:
    v_max3_f32 v248, v96, v97, v98
    v_max3_f32 v249, v99, v100, v101
    v_max3_f32 v250, v102, v103, v104
    v_max3_f32 v251, v105, v106, v107
    v_max3_f32 v248, v248, v249, v250
    v_max3_f32 v252, v108, v109, v110
    v_max3_f32 v248, v248, v251, v111
    v_max_f32 v248, v248, v252
    v_mov_b32 v249, v248
    s_nop 1
    v_permlane32_swap_b32 v248, v249
    v_max_f32 v248, v248, v249
    v_mov_b32 v249, v248
    s_nop 1
    v_permlane16_swap_b32 v248, v249
    v_max3_f32 v248, v248, v249, v156
    v_mov_b32 v156, 0
    v_mov_b32 v150, s50
    v_sub_f32 v249, 0, v248
    v_exp_f32 v249, v249
    v_sub_f32 v144, v144, v248
    v_sub_f32 v145, v145, v248
    v_sub_f32 v146, v146, v248
    v_sub_f32 v147, v147, v248
    v_min_f32 v249, v249, s50
    v_mul_f32 v153, v153, v249
    s_nop 7
    v_accvgpr_read_b32 v250, a64
    v_mul_f32 v250, v250, v249
    v_accvgpr_write_b32 a64, v250
    v_accvgpr_read_b32 v251, a65
    v_mul_f32 v251, v251, v249
    v_accvgpr_write_b32 a65, v251
    v_accvgpr_read_b32 v252, a66
    v_mul_f32 v252, v252, v249
    v_accvgpr_write_b32 a66, v252
    v_accvgpr_read_b32 v253, a67
    v_mul_f32 v253, v253, v249
    v_accvgpr_write_b32 a67, v253
    v_accvgpr_read_b32 v250, a68
    v_mul_f32 v250, v250, v249
    v_accvgpr_write_b32 a68, v250
    v_accvgpr_read_b32 v251, a69
    v_mul_f32 v251, v251, v249
    v_accvgpr_write_b32 a69, v251
    v_accvgpr_read_b32 v252, a70
    v_mul_f32 v252, v252, v249
    v_accvgpr_write_b32 a70, v252
    v_accvgpr_read_b32 v253, a71
    v_mul_f32 v253, v253, v249
    v_accvgpr_write_b32 a71, v253
    v_accvgpr_read_b32 v250, a72
    v_mul_f32 v250, v250, v249
    v_accvgpr_write_b32 a72, v250
    v_accvgpr_read_b32 v251, a73
    v_mul_f32 v251, v251, v249
    v_accvgpr_write_b32 a73, v251
    v_accvgpr_read_b32 v252, a74
    v_mul_f32 v252, v252, v249
    v_accvgpr_write_b32 a74, v252
    v_accvgpr_read_b32 v253, a75
    v_mul_f32 v253, v253, v249
    v_accvgpr_write_b32 a75, v253
    v_accvgpr_read_b32 v250, a76
    v_mul_f32 v250, v250, v249
    v_accvgpr_write_b32 a76, v250
    v_accvgpr_read_b32 v251, a77
    v_mul_f32 v251, v251, v249
    v_accvgpr_write_b32 a77, v251
    v_accvgpr_read_b32 v252, a78
    v_mul_f32 v252, v252, v249
    v_accvgpr_write_b32 a78, v252
    v_accvgpr_read_b32 v253, a79
    v_mul_f32 v253, v253, v249
    v_accvgpr_write_b32 a79, v253
    v_accvgpr_read_b32 v250, a80
    v_mul_f32 v250, v250, v249
    v_accvgpr_write_b32 a80, v250
    v_accvgpr_read_b32 v251, a81
    v_mul_f32 v251, v251, v249
    v_accvgpr_write_b32 a81, v251
    v_accvgpr_read_b32 v252, a82
    v_mul_f32 v252, v252, v249
    v_accvgpr_write_b32 a82, v252
    v_accvgpr_read_b32 v253, a83
    v_mul_f32 v253, v253, v249
    v_accvgpr_write_b32 a83, v253
    v_accvgpr_read_b32 v250, a84
    v_mul_f32 v250, v250, v249
    v_accvgpr_write_b32 a84, v250
    v_accvgpr_read_b32 v251, a85
    v_mul_f32 v251, v251, v249
    v_accvgpr_write_b32 a85, v251
    v_accvgpr_read_b32 v252, a86
    v_mul_f32 v252, v252, v249
    v_accvgpr_write_b32 a86, v252
    v_accvgpr_read_b32 v253, a87
    v_mul_f32 v253, v253, v249
    v_accvgpr_write_b32 a87, v253
    v_accvgpr_read_b32 v250, a88
    v_mul_f32 v250, v250, v249
    v_accvgpr_write_b32 a88, v250
    v_accvgpr_read_b32 v251, a89
    v_mul_f32 v251, v251, v249
    v_accvgpr_write_b32 a89, v251
    v_accvgpr_read_b32 v252, a90
    v_mul_f32 v252, v252, v249
    v_accvgpr_write_b32 a90, v252
    v_accvgpr_read_b32 v253, a91
    v_mul_f32 v253, v253, v249
    v_accvgpr_write_b32 a91, v253
    v_accvgpr_read_b32 v250, a92
    v_mul_f32 v250, v250, v249
    v_accvgpr_write_b32 a92, v250
    v_accvgpr_read_b32 v251, a93
    v_mul_f32 v251, v251, v249
    v_accvgpr_write_b32 a93, v251
    v_accvgpr_read_b32 v252, a94
    v_mul_f32 v252, v252, v249
    v_accvgpr_write_b32 a94, v252
    v_accvgpr_read_b32 v253, a95
    v_mul_f32 v253, v253, v249
    v_accvgpr_write_b32 a95, v253
    v_sub_f32 v216, v96, v248
    v_sub_f32 v217, v97, v248
    v_sub_f32 v218, v98, v248
    v_sub_f32 v219, v99, v248
    v_sub_f32 v220, v100, v248
    v_sub_f32 v221, v101, v248
    v_sub_f32 v222, v102, v248
    v_sub_f32 v223, v103, v248
    v_sub_f32 v224, v104, v248
    v_sub_f32 v225, v105, v248
    v_sub_f32 v226, v106, v248
    v_sub_f32 v227, v107, v248
    v_sub_f32 v228, v108, v248
    v_sub_f32 v229, v109, v248
    v_sub_f32 v230, v110, v248
    v_sub_f32 v231, v111, v248
    v_exp_f32 v216, v216
    v_exp_f32 v217, v217
    v_exp_f32 v218, v218
    v_exp_f32 v219, v219
    v_exp_f32 v220, v220
    v_exp_f32 v221, v221
    v_exp_f32 v222, v222
    v_exp_f32 v223, v223
    v_exp_f32 v224, v224
    v_exp_f32 v225, v225
    v_exp_f32 v226, v226
    v_exp_f32 v227, v227
    v_exp_f32 v228, v228
    v_exp_f32 v229, v229
    v_exp_f32 v230, v230
    v_exp_f32 v231, v231
    s_nop 0
    v_add_f32 v248, v216, v217
    v_add_f32 v248, v248, v218
    v_add_f32 v248, v248, v219
    v_add_f32 v248, v248, v220
    v_add_f32 v248, v248, v221
    v_add_f32 v248, v248, v222
    v_add_f32 v248, v248, v223
    v_add_f32 v248, v248, v224
    v_add_f32 v248, v248, v225
    v_add_f32 v248, v248, v226
    v_add_f32 v248, v248, v227
    v_add_f32 v248, v248, v228
    v_add_f32 v248, v248, v229
    v_add_f32 v248, v248, v230
    v_add_f32 v248, v248, v231
    s_branch A_BACK_2
A_SLOW_2T:
    v_max3_f32 v248, v96, v97, v98
    v_max3_f32 v249, v99, v100, v101
    v_max3_f32 v250, v102, v103, v104
    v_max3_f32 v251, v105, v106, v107
    v_max3_f32 v248, v248, v249, v250
    v_max3_f32 v252, v108, v109, v110
    v_max3_f32 v248, v248, v251, v111
    v_max_f32 v248, v248, v252
    v_mov_b32 v249, v248
    s_nop 1
    v_permlane32_swap_b32 v248, v249
    v_max_f32 v248, v248, v249
    v_mov_b32 v249, v248
    s_nop 1
    v_permlane16_swap_b32 v248, v249
    v_max3_f32 v248, v248, v249, v156
    v_mov_b32 v156, 0
    v_mov_b32 v150, s50
    v_sub_f32 v249, 0, v248
    v_exp_f32 v249, v249
    v_sub_f32 v144, v144, v248
    v_sub_f32 v145, v145, v248
    v_sub_f32 v146, v146, v248
    v_sub_f32 v147, v147, v248
    v_min_f32 v249, v249, s50
    v_mul_f32 v153, v153, v249
    s_nop 7
    v_accvgpr_read_b32 v250, a64
    v_mul_f32 v250, v250, v249
    v_accvgpr_write_b32 a64, v250
    v_accvgpr_read_b32 v251, a65
    v_mul_f32 v251, v251, v249
    v_accvgpr_write_b32 a65, v251
    v_accvgpr_read_b32 v252, a66
    v_mul_f32 v252, v252, v249
    v_accvgpr_write_b32 a66, v252
    v_accvgpr_read_b32 v253, a67
    v_mul_f32 v253, v253, v249
    v_accvgpr_write_b32 a67, v253
    v_accvgpr_read_b32 v250, a68
    v_mul_f32 v250, v250, v249
    v_accvgpr_write_b32 a68, v250
    v_accvgpr_read_b32 v251, a69
    v_mul_f32 v251, v251, v249
    v_accvgpr_write_b32 a69, v251
    v_accvgpr_read_b32 v252, a70
    v_mul_f32 v252, v252, v249
    v_accvgpr_write_b32 a70, v252
    v_accvgpr_read_b32 v253, a71
    v_mul_f32 v253, v253, v249
    v_accvgpr_write_b32 a71, v253
    v_accvgpr_read_b32 v250, a72
    v_mul_f32 v250, v250, v249
    v_accvgpr_write_b32 a72, v250
    v_accvgpr_read_b32 v251, a73
    v_mul_f32 v251, v251, v249
    v_accvgpr_write_b32 a73, v251
    v_accvgpr_read_b32 v252, a74
    v_mul_f32 v252, v252, v249
    v_accvgpr_write_b32 a74, v252
    v_accvgpr_read_b32 v253, a75
    v_mul_f32 v253, v253, v249
    v_accvgpr_write_b32 a75, v253
    v_accvgpr_read_b32 v250, a76
    v_mul_f32 v250, v250, v249
    v_accvgpr_write_b32 a76, v250
    v_accvgpr_read_b32 v251, a77
    v_mul_f32 v251, v251, v249
    v_accvgpr_write_b32 a77, v251
    v_accvgpr_read_b32 v252, a78
    v_mul_f32 v252, v252, v249
    v_accvgpr_write_b32 a78, v252
    v_accvgpr_read_b32 v253, a79
    v_mul_f32 v253, v253, v249
    v_accvgpr_write_b32 a79, v253
    v_accvgpr_read_b32 v250, a80
    v_mul_f32 v250, v250, v249
    v_accvgpr_write_b32 a80, v250
    v_accvgpr_read_b32 v251, a81
    v_mul_f32 v251, v251, v249
    v_accvgpr_write_b32 a81, v251
    v_accvgpr_read_b32 v252, a82
    v_mul_f32 v252, v252, v249
    v_accvgpr_write_b32 a82, v252
    v_accvgpr_read_b32 v253, a83
    v_mul_f32 v253, v253, v249
    v_accvgpr_write_b32 a83, v253
    v_accvgpr_read_b32 v250, a84
    v_mul_f32 v250, v250, v249
    v_accvgpr_write_b32 a84, v250
    v_accvgpr_read_b32 v251, a85
    v_mul_f32 v251, v251, v249
    v_accvgpr_write_b32 a85, v251
    v_accvgpr_read_b32 v252, a86
    v_mul_f32 v252, v252, v249
    v_accvgpr_write_b32 a86, v252
    v_accvgpr_read_b32 v253, a87
    v_mul_f32 v253, v253, v249
    v_accvgpr_write_b32 a87, v253
    v_accvgpr_read_b32 v250, a88
    v_mul_f32 v250, v250, v249
    v_accvgpr_write_b32 a88, v250
    v_accvgpr_read_b32 v251, a89
    v_mul_f32 v251, v251, v249
    v_accvgpr_write_b32 a89, v251
    v_accvgpr_read_b32 v252, a90
    v_mul_f32 v252, v252, v249
    v_accvgpr_write_b32 a90, v252
    v_accvgpr_read_b32 v253, a91
    v_mul_f32 v253, v253, v249
    v_accvgpr_write_b32 a91, v253
    v_accvgpr_read_b32 v250, a92
    v_mul_f32 v250, v250, v249
    v_accvgpr_write_b32 a92, v250
    v_accvgpr_read_b32 v251, a93
    v_mul_f32 v251, v251, v249
    v_accvgpr_write_b32 a93, v251
    v_accvgpr_read_b32 v252, a94
    v_mul_f32 v252, v252, v249
    v_accvgpr_write_b32 a94, v252
    v_accvgpr_read_b32 v253, a95
    v_mul_f32 v253, v253, v249
    v_accvgpr_write_b32 a95, v253
    v_sub_f32 v216, v96, v248
    v_sub_f32 v217, v97, v248
    v_sub_f32 v218, v98, v248
    v_sub_f32 v219, v99, v248
    v_sub_f32 v220, v100, v248
    v_sub_f32 v221, v101, v248
    v_sub_f32 v222, v102, v248
    v_sub_f32 v223, v103, v248
    v_sub_f32 v224, v104, v248
    v_sub_f32 v225, v105, v248
    v_sub_f32 v226, v106, v248
    v_sub_f32 v227, v107, v248
    v_sub_f32 v228, v108, v248
    v_sub_f32 v229, v109, v248
    v_sub_f32 v230, v110, v248
    v_sub_f32 v231, v111, v248
    v_exp_f32 v216, v216
    v_exp_f32 v217, v217
    v_exp_f32 v218, v218
    v_exp_f32 v219, v219
    v_exp_f32 v220, v220
    v_exp_f32 v221, v221
    v_exp_f32 v222, v222
    v_exp_f32 v223, v223
    v_exp_f32 v224, v224
    v_exp_f32 v225, v225
    v_exp_f32 v226, v226
    v_exp_f32 v227, v227
    v_exp_f32 v228, v228
    v_exp_f32 v229, v229
    v_exp_f32 v230, v230
    v_exp_f32 v231, v231
    s_nop 0
    v_add_f32 v248, v216, v217
    v_add_f32 v248, v248, v218
    v_add_f32 v248, v248, v219
    v_add_f32 v248, v248, v220
    v_add_f32 v248, v248, v221
    v_add_f32 v248, v248, v222
    v_add_f32 v248, v248, v223
    v_add_f32 v248, v248, v224
    v_add_f32 v248, v248, v225
    v_add_f32 v248, v248, v226
    v_add_f32 v248, v248, v227
    v_add_f32 v248, v248, v228
    v_add_f32 v248, v248, v229
    v_add_f32 v248, v248, v230
    v_add_f32 v248, v248, v231
    s_branch A_BACK_2T
A_LOADER:
    v_lshlrev_b32 v3, 2, v1
    v_or_b32 v3, 0, v3
    v_xor_b32 v3, v3, v2
    v_lshlrev_b32 v3, 4, v3
    v_lshl_add_u32 v4, v1, 8, v3
    v_lshlrev_b32 v3, 2, v1
    v_or_b32 v3, 1, v3
    v_xor_b32 v3, v3, v2
    v_lshlrev_b32 v3, 4, v3
    v_lshl_add_u32 v5, v1, 8, v3
    v_lshlrev_b32 v3, 2, v1
    v_or_b32 v3, 2, v3
    v_xor_b32 v3, v3, v2
    v_lshlrev_b32 v3, 4, v3
    v_lshl_add_u32 v6, v1, 8, v3
    v_lshlrev_b32 v3, 2, v1
    v_or_b32 v3, 3, v3
    v_xor_b32 v3, v3, v2
    v_lshlrev_b32 v3, 4, v3
    v_lshl_add_u32 v7, v1, 8, v3
    v_or_b32 v3, 0, v1
    v_lshlrev_b32 v3, 1, v3
    v_xor_b32 v3, v3, v2
    v_lshlrev_b32 v3, 4, v3
    v_lshl_add_u32 v8, v1, 8, v3
    v_or_b32 v3, 4, v1
    v_lshlrev_b32 v3, 1, v3
    v_xor_b32 v3, v3, v2
    v_lshlrev_b32 v3, 4, v3
    v_lshl_add_u32 v9, v1, 8, v3
    v_xor_b32 v3, v2, v1
    v_lshlrev_b32 v3, 4, v3
    v_lshl_add_u32 v10, v1, 13, v3
    s_waitcnt vmcnt(59)
    s_mov_b32 m0, 98304
    s_add_u32 s47, s46, 0
    s_and_b32 s47, s47, 15
    s_lshl_b32 s47, s47, 18
    s_add_u32 s17, s47, 0
    buffer_load_dwordx4 v10, s[32:35], s17 offen offset:0 lds
    s_add_u32 s17, s47, 31744
    buffer_load_dwordx4 v10, s[32:35], s17 offen offset:1024 lds
    s_add_u32 s17, s47, 63488
    buffer_load_dwordx4 v10, s[32:35], s17 offen offset:2048 lds
    s_add_u32 s17, s47, 95232
    buffer_load_dwordx4 v10, s[32:35], s17 offen offset:3072 lds
    s_waitcnt vmcnt(59)
    s_mov_b32 m0, 102400
    s_add_u32 s47, s46, 0
    s_and_b32 s47, s47, 15
    s_lshl_b32 s47, s47, 18
    s_add_u32 s17, s47, 131072
    buffer_load_dwordx4 v10, s[32:35], s17 offen offset:0 lds
    s_add_u32 s17, s47, 162816
    buffer_load_dwordx4 v10, s[32:35], s17 offen offset:1024 lds
    s_add_u32 s17, s47, 194560
    buffer_load_dwordx4 v10, s[32:35], s17 offen offset:2048 lds
    s_add_u32 s17, s47, 226304
    buffer_load_dwordx4 v10, s[32:35], s17 offen offset:3072 lds
    s_waitcnt vmcnt(59)
    s_mov_b32 m0, 106496
    s_add_u32 s47, s46, 1
    s_and_b32 s47, s47, 15
    s_lshl_b32 s47, s47, 18
    s_add_u32 s17, s47, 0
    buffer_load_dwordx4 v10, s[32:35], s17 offen offset:0 lds
    s_add_u32 s17, s47, 31744
    buffer_load_dwordx4 v10, s[32:35], s17 offen offset:1024 lds
    s_add_u32 s17, s47, 63488
    buffer_load_dwordx4 v10, s[32:35], s17 offen offset:2048 lds
    s_add_u32 s17, s47, 95232
    buffer_load_dwordx4 v10, s[32:35], s17 offen offset:3072 lds
    s_waitcnt vmcnt(59)
    s_mov_b32 m0, 110592
    s_add_u32 s47, s46, 1
    s_and_b32 s47, s47, 15
    s_lshl_b32 s47, s47, 18
    s_add_u32 s17, s47, 131072
    buffer_load_dwordx4 v10, s[32:35], s17 offen offset:0 lds
    s_add_u32 s17, s47, 162816
    buffer_load_dwordx4 v10, s[32:35], s17 offen offset:1024 lds
    s_add_u32 s17, s47, 194560
    buffer_load_dwordx4 v10, s[32:35], s17 offen offset:2048 lds
    s_add_u32 s17, s47, 226304
    buffer_load_dwordx4 v10, s[32:35], s17 offen offset:3072 lds
    s_waitcnt vmcnt(59)
    s_mov_b32 m0, 114688
    s_add_u32 s47, s46, 2
    s_and_b32 s47, s47, 15
    s_lshl_b32 s47, s47, 18
    s_add_u32 s17, s47, 0
    buffer_load_dwordx4 v10, s[32:35], s17 offen offset:0 lds
    s_add_u32 s17, s47, 31744
    buffer_load_dwordx4 v10, s[32:35], s17 offen offset:1024 lds
    s_add_u32 s17, s47, 63488
    buffer_load_dwordx4 v10, s[32:35], s17 offen offset:2048 lds
    s_add_u32 s17, s47, 95232
    buffer_load_dwordx4 v10, s[32:35], s17 offen offset:3072 lds
    s_waitcnt vmcnt(59)
    s_mov_b32 m0, 118784
    s_add_u32 s47, s46, 2
    s_and_b32 s47, s47, 15
    s_lshl_b32 s47, s47, 18
    s_add_u32 s17, s47, 131072
    buffer_load_dwordx4 v10, s[32:35], s17 offen offset:0 lds
    s_add_u32 s17, s47, 162816
    buffer_load_dwordx4 v10, s[32:35], s17 offen offset:1024 lds
    s_add_u32 s17, s47, 194560
    buffer_load_dwordx4 v10, s[32:35], s17 offen offset:2048 lds
    s_add_u32 s17, s47, 226304
    buffer_load_dwordx4 v10, s[32:35], s17 offen offset:3072 lds
    s_waitcnt vmcnt(59)
    s_mov_b32 m0, 122880
    s_add_u32 s47, s46, 3
    s_and_b32 s47, s47, 15
    s_lshl_b32 s47, s47, 18
    s_add_u32 s17, s47, 0
    buffer_load_dwordx4 v10, s[32:35], s17 offen offset:0 lds
    s_add_u32 s17, s47, 31744
    buffer_load_dwordx4 v10, s[32:35], s17 offen offset:1024 lds
    s_add_u32 s17, s47, 63488
    buffer_load_dwordx4 v10, s[32:35], s17 offen offset:2048 lds
    s_add_u32 s17, s47, 95232
    buffer_load_dwordx4 v10, s[32:35], s17 offen offset:3072 lds
    s_waitcnt vmcnt(59)
    s_mov_b32 m0, 126976
    s_add_u32 s47, s46, 3
    s_and_b32 s47, s47, 15
    s_lshl_b32 s47, s47, 18
    s_add_u32 s17, s47, 131072
    buffer_load_dwordx4 v10, s[32:35], s17 offen offset:0 lds
    s_add_u32 s17, s47, 162816
    buffer_load_dwordx4 v10, s[32:35], s17 offen offset:1024 lds
    s_add_u32 s17, s47, 194560
    buffer_load_dwordx4 v10, s[32:35], s17 offen offset:2048 lds
    s_add_u32 s17, s47, 226304
    buffer_load_dwordx4 v10, s[32:35], s17 offen offset:3072 lds
    s_waitcnt vmcnt(59)
    s_mov_b32 m0, 131072
    s_add_u32 s47, s46, 4
    s_and_b32 s47, s47, 15
    s_lshl_b32 s47, s47, 18
    s_add_u32 s17, s47, 0
    buffer_load_dwordx4 v10, s[32:35], s17 offen offset:0 lds
    s_add_u32 s17, s47, 31744
    buffer_load_dwordx4 v10, s[32:35], s17 offen offset:1024 lds
    s_add_u32 s17, s47, 63488
    buffer_load_dwordx4 v10, s[32:35], s17 offen offset:2048 lds
    s_add_u32 s17, s47, 95232
    buffer_load_dwordx4 v10, s[32:35], s17 offen offset:3072 lds
    s_waitcnt vmcnt(59)
    s_mov_b32 m0, 135168
    s_add_u32 s47, s46, 4
    s_and_b32 s47, s47, 15
    s_lshl_b32 s47, s47, 18
    s_add_u32 s17, s47, 131072
    buffer_load_dwordx4 v10, s[32:35], s17 offen offset:0 lds
    s_add_u32 s17, s47, 162816
    buffer_load_dwordx4 v10, s[32:35], s17 offen offset:1024 lds
    s_add_u32 s17, s47, 194560
    buffer_load_dwordx4 v10, s[32:35], s17 offen offset:2048 lds
    s_add_u32 s17, s47, 226304
    buffer_load_dwordx4 v10, s[32:35], s17 offen offset:3072 lds
    s_waitcnt vmcnt(59)
    s_mov_b32 m0, 139264
    s_add_u32 s47, s46, 5
    s_and_b32 s47, s47, 15
    s_lshl_b32 s47, s47, 18
    s_add_u32 s17, s47, 0
    buffer_load_dwordx4 v10, s[32:35], s17 offen offset:0 lds
    s_add_u32 s17, s47, 31744
    buffer_load_dwordx4 v10, s[32:35], s17 offen offset:1024 lds
    s_add_u32 s17, s47, 63488
    buffer_load_dwordx4 v10, s[32:35], s17 offen offset:2048 lds
    s_add_u32 s17, s47, 95232
    buffer_load_dwordx4 v10, s[32:35], s17 offen offset:3072 lds
    s_waitcnt vmcnt(59)
    s_mov_b32 m0, 143360
    s_add_u32 s47, s46, 5
    s_and_b32 s47, s47, 15
    s_lshl_b32 s47, s47, 18
    s_add_u32 s17, s47, 131072
    buffer_load_dwordx4 v10, s[32:35], s17 offen offset:0 lds
    s_add_u32 s17, s47, 162816
    buffer_load_dwordx4 v10, s[32:35], s17 offen offset:1024 lds
    s_add_u32 s17, s47, 194560
    buffer_load_dwordx4 v10, s[32:35], s17 offen offset:2048 lds
    s_add_u32 s17, s47, 226304
    buffer_load_dwordx4 v10, s[32:35], s17 offen offset:3072 lds
    s_waitcnt vmcnt(59)
    s_mov_b32 m0, 147456
    s_add_u32 s47, s46, 6
    s_and_b32 s47, s47, 15
    s_lshl_b32 s47, s47, 18
    s_add_u32 s17, s47, 0
    buffer_load_dwordx4 v10, s[32:35], s17 offen offset:0 lds
    s_add_u32 s17, s47, 31744
    buffer_load_dwordx4 v10, s[32:35], s17 offen offset:1024 lds
    s_add_u32 s17, s47, 63488
    buffer_load_dwordx4 v10, s[32:35], s17 offen offset:2048 lds
    s_add_u32 s17, s47, 95232
    buffer_load_dwordx4 v10, s[32:35], s17 offen offset:3072 lds
    s_waitcnt vmcnt(59)
    s_mov_b32 m0, 151552
    s_add_u32 s47, s46, 6
    s_and_b32 s47, s47, 15
    s_lshl_b32 s47, s47, 18
    s_add_u32 s17, s47, 131072
    buffer_load_dwordx4 v10, s[32:35], s17 offen offset:0 lds
    s_add_u32 s17, s47, 162816
    buffer_load_dwordx4 v10, s[32:35], s17 offen offset:1024 lds
    s_add_u32 s17, s47, 194560
    buffer_load_dwordx4 v10, s[32:35], s17 offen offset:2048 lds
    s_add_u32 s17, s47, 226304
    buffer_load_dwordx4 v10, s[32:35], s17 offen offset:3072 lds
    s_waitcnt vmcnt(59)
    s_mov_b32 m0, 155648
    s_add_u32 s47, s46, 7
    s_and_b32 s47, s47, 15
    s_lshl_b32 s47, s47, 18
    s_add_u32 s17, s47, 0
    buffer_load_dwordx4 v10, s[32:35], s17 offen offset:0 lds
    s_add_u32 s17, s47, 31744
    buffer_load_dwordx4 v10, s[32:35], s17 offen offset:1024 lds
    s_add_u32 s17, s47, 63488
    buffer_load_dwordx4 v10, s[32:35], s17 offen offset:2048 lds
    s_add_u32 s17, s47, 95232
    buffer_load_dwordx4 v10, s[32:35], s17 offen offset:3072 lds
    s_waitcnt vmcnt(59)
    s_mov_b32 m0, 159744
    s_add_u32 s47, s46, 7
    s_and_b32 s47, s47, 15
    s_lshl_b32 s47, s47, 18
    s_add_u32 s17, s47, 131072
    buffer_load_dwordx4 v10, s[32:35], s17 offen offset:0 lds
    s_add_u32 s17, s47, 162816
    buffer_load_dwordx4 v10, s[32:35], s17 offen offset:1024 lds
    s_add_u32 s17, s47, 194560
    buffer_load_dwordx4 v10, s[32:35], s17 offen offset:2048 lds
    s_add_u32 s17, s47, 226304
    buffer_load_dwordx4 v10, s[32:35], s17 offen offset:3072 lds
    s_waitcnt vmcnt(56)
    s_barrier
    s_waitcnt vmcnt(48)
    s_barrier
    s_waitcnt vmcnt(59)
    s_mov_b32 m0, 98304
    s_add_u32 s47, s46, 8
    s_and_b32 s47, s47, 15
    s_lshl_b32 s47, s47, 18
    s_add_u32 s17, s47, 0
    buffer_load_dwordx4 v10, s[32:35], s17 offen offset:0 lds
    s_add_u32 s17, s47, 31744
    buffer_load_dwordx4 v10, s[32:35], s17 offen offset:1024 lds
    s_add_u32 s17, s47, 63488
    buffer_load_dwordx4 v10, s[32:35], s17 offen offset:2048 lds
    s_add_u32 s17, s47, 95232
    buffer_load_dwordx4 v10, s[32:35], s17 offen offset:3072 lds
    s_waitcnt vmcnt(59)
    s_mov_b32 m0, 102400
    s_add_u32 s47, s46, 8
    s_and_b32 s47, s47, 15
    s_lshl_b32 s47, s47, 18
    s_add_u32 s17, s47, 131072
    buffer_load_dwordx4 v10, s[32:35], s17 offen offset:0 lds
    s_add_u32 s17, s47, 162816
    buffer_load_dwordx4 v10, s[32:35], s17 offen offset:1024 lds
    s_add_u32 s17, s47, 194560
    buffer_load_dwordx4 v10, s[32:35], s17 offen offset:2048 lds
    s_add_u32 s17, s47, 226304
    buffer_load_dwordx4 v10, s[32:35], s17 offen offset:3072 lds
    s_waitcnt vmcnt(48)
    s_barrier
    s_waitcnt vmcnt(59)
    s_mov_b32 m0, 106496
    s_add_u32 s47, s46, 9
    s_and_b32 s47, s47, 15
    s_lshl_b32 s47, s47, 18
    s_add_u32 s17, s47, 0
    buffer_load_dwordx4 v10, s[32:35], s17 offen offset:0 lds
    s_add_u32 s17, s47, 31744
    buffer_load_dwordx4 v10, s[32:35], s17 offen offset:1024 lds
    s_add_u32 s17, s47, 63488
    buffer_load_dwordx4 v10, s[32:35], s17 offen offset:2048 lds
    s_add_u32 s17, s47, 95232
    buffer_load_dwordx4 v10, s[32:35], s17 offen offset:3072 lds
    s_waitcnt vmcnt(59)
    s_mov_b32 m0, 110592
    s_add_u32 s47, s46, 9
    s_and_b32 s47, s47, 15
    s_lshl_b32 s47, s47, 18
    s_add_u32 s17, s47, 131072
    buffer_load_dwordx4 v10, s[32:35], s17 offen offset:0 lds
    s_add_u32 s17, s47, 162816
    buffer_load_dwordx4 v10, s[32:35], s17 offen offset:1024 lds
    s_add_u32 s17, s47, 194560
    buffer_load_dwordx4 v10, s[32:35], s17 offen offset:2048 lds
    s_add_u32 s17, s47, 226304
    buffer_load_dwordx4 v10, s[32:35], s17 offen offset:3072 lds
    s_waitcnt vmcnt(48)
    s_barrier
    s_waitcnt vmcnt(59)
    s_mov_b32 m0, 114688
    s_add_u32 s47, s46, 10
    s_and_b32 s47, s47, 15
    s_lshl_b32 s47, s47, 18
    s_add_u32 s17, s47, 0
    buffer_load_dwordx4 v10, s[32:35], s17 offen offset:0 lds
    s_add_u32 s17, s47, 31744
    buffer_load_dwordx4 v10, s[32:35], s17 offen offset:1024 lds
    s_add_u32 s17, s47, 63488
    buffer_load_dwordx4 v10, s[32:35], s17 offen offset:2048 lds
    s_add_u32 s17, s47, 95232
    buffer_load_dwordx4 v10, s[32:35], s17 offen offset:3072 lds
    s_waitcnt vmcnt(59)
    s_mov_b32 m0, 118784
    s_add_u32 s47, s46, 10
    s_and_b32 s47, s47, 15
    s_lshl_b32 s47, s47, 18
    s_add_u32 s17, s47, 131072
    buffer_load_dwordx4 v10, s[32:35], s17 offen offset:0 lds
    s_add_u32 s17, s47, 162816
    buffer_load_dwordx4 v10, s[32:35], s17 offen offset:1024 lds
    s_add_u32 s17, s47, 194560
    buffer_load_dwordx4 v10, s[32:35], s17 offen offset:2048 lds
    s_add_u32 s17, s47, 226304
    buffer_load_dwordx4 v10, s[32:35], s17 offen offset:3072 lds
    s_waitcnt vmcnt(48)
    s_barrier
    s_waitcnt vmcnt(59)
    s_mov_b32 m0, 122880
    s_add_u32 s47, s46, 11
    s_and_b32 s47, s47, 15
    s_lshl_b32 s47, s47, 18
    s_add_u32 s17, s47, 0
    buffer_load_dwordx4 v10, s[32:35], s17 offen offset:0 lds
    s_add_u32 s17, s47, 31744
    buffer_load_dwordx4 v10, s[32:35], s17 offen offset:1024 lds
    s_add_u32 s17, s47, 63488
    buffer_load_dwordx4 v10, s[32:35], s17 offen offset:2048 lds
    s_add_u32 s17, s47, 95232
    buffer_load_dwordx4 v10, s[32:35], s17 offen offset:3072 lds
    s_waitcnt vmcnt(59)
    s_mov_b32 m0, 126976
    s_add_u32 s47, s46, 11
    s_and_b32 s47, s47, 15
    s_lshl_b32 s47, s47, 18
    s_add_u32 s17, s47, 131072
    buffer_load_dwordx4 v10, s[32:35], s17 offen offset:0 lds
    s_add_u32 s17, s47, 162816
    buffer_load_dwordx4 v10, s[32:35], s17 offen offset:1024 lds
    s_add_u32 s17, s47, 194560
    buffer_load_dwordx4 v10, s[32:35], s17 offen offset:2048 lds
    s_add_u32 s17, s47, 226304
    buffer_load_dwordx4 v10, s[32:35], s17 offen offset:3072 lds
    s_waitcnt vmcnt(48)
    s_barrier
    s_waitcnt vmcnt(59)
    s_mov_b32 m0, 131072
    s_add_u32 s47, s46, 12
    s_and_b32 s47, s47, 15
    s_lshl_b32 s47, s47, 18
    s_add_u32 s17, s47, 0
    buffer_load_dwordx4 v10, s[32:35], s17 offen offset:0 lds
    s_add_u32 s17, s47, 31744
    buffer_load_dwordx4 v10, s[32:35], s17 offen offset:1024 lds
    s_add_u32 s17, s47, 63488
    buffer_load_dwordx4 v10, s[32:35], s17 offen offset:2048 lds
    s_add_u32 s17, s47, 95232
    buffer_load_dwordx4 v10, s[32:35], s17 offen offset:3072 lds
    s_waitcnt vmcnt(59)
    s_mov_b32 m0, 135168
    s_add_u32 s47, s46, 12
    s_and_b32 s47, s47, 15
    s_lshl_b32 s47, s47, 18
    s_add_u32 s17, s47, 131072
    buffer_load_dwordx4 v10, s[32:35], s17 offen offset:0 lds
    s_add_u32 s17, s47, 162816
    buffer_load_dwordx4 v10, s[32:35], s17 offen offset:1024 lds
    s_add_u32 s17, s47, 194560
    buffer_load_dwordx4 v10, s[32:35], s17 offen offset:2048 lds
    s_add_u32 s17, s47, 226304
    buffer_load_dwordx4 v10, s[32:35], s17 offen offset:3072 lds
    s_waitcnt vmcnt(48)
    s_barrier
    s_waitcnt vmcnt(59)
    s_mov_b32 m0, 139264
    s_add_u32 s47, s46, 13
    s_and_b32 s47, s47, 15
    s_lshl_b32 s47, s47, 18
    s_add_u32 s17, s47, 0
    buffer_load_dwordx4 v10, s[32:35], s17 offen offset:0 lds
    s_add_u32 s17, s47, 31744
    buffer_load_dwordx4 v10, s[32:35], s17 offen offset:1024 lds
    s_add_u32 s17, s47, 63488
    buffer_load_dwordx4 v10, s[32:35], s17 offen offset:2048 lds
    s_add_u32 s17, s47, 95232
    buffer_load_dwordx4 v10, s[32:35], s17 offen offset:3072 lds
    s_waitcnt vmcnt(59)
    s_mov_b32 m0, 143360
    s_add_u32 s47, s46, 13
    s_and_b32 s47, s47, 15
    s_lshl_b32 s47, s47, 18
    s_add_u32 s17, s47, 131072
    buffer_load_dwordx4 v10, s[32:35], s17 offen offset:0 lds
    s_add_u32 s17, s47, 162816
    buffer_load_dwordx4 v10, s[32:35], s17 offen offset:1024 lds
    s_add_u32 s17, s47, 194560
    buffer_load_dwordx4 v10, s[32:35], s17 offen offset:2048 lds
    s_add_u32 s17, s47, 226304
    buffer_load_dwordx4 v10, s[32:35], s17 offen offset:3072 lds
    s_waitcnt vmcnt(48)
    s_barrier
    s_waitcnt vmcnt(59)
    s_mov_b32 m0, 147456
    s_add_u32 s47, s46, 14
    s_and_b32 s47, s47, 15
    s_lshl_b32 s47, s47, 18
    s_add_u32 s17, s47, 0
    buffer_load_dwordx4 v10, s[32:35], s17 offen offset:0 lds
    s_add_u32 s17, s47, 31744
    buffer_load_dwordx4 v10, s[32:35], s17 offen offset:1024 lds
    s_add_u32 s17, s47, 63488
    buffer_load_dwordx4 v10, s[32:35], s17 offen offset:2048 lds
    s_add_u32 s17, s47, 95232
    buffer_load_dwordx4 v10, s[32:35], s17 offen offset:3072 lds
    s_waitcnt vmcnt(59)
    s_mov_b32 m0, 151552
    s_add_u32 s47, s46, 14
    s_and_b32 s47, s47, 15
    s_lshl_b32 s47, s47, 18
    s_add_u32 s17, s47, 131072
    buffer_load_dwordx4 v10, s[32:35], s17 offen offset:0 lds
    s_add_u32 s17, s47, 162816
    buffer_load_dwordx4 v10, s[32:35], s17 offen offset:1024 lds
    s_add_u32 s17, s47, 194560
    buffer_load_dwordx4 v10, s[32:35], s17 offen offset:2048 lds
    s_add_u32 s17, s47, 226304
    buffer_load_dwordx4 v10, s[32:35], s17 offen offset:3072 lds
    s_waitcnt vmcnt(48)
    s_barrier
    s_waitcnt vmcnt(59)
    s_mov_b32 m0, 155648
    s_add_u32 s47, s46, 15
    s_and_b32 s47, s47, 15
    s_lshl_b32 s47, s47, 18
    s_add_u32 s17, s47, 0
    buffer_load_dwordx4 v10, s[32:35], s17 offen offset:0 lds
    s_add_u32 s17, s47, 31744
    buffer_load_dwordx4 v10, s[32:35], s17 offen offset:1024 lds
    s_add_u32 s17, s47, 63488
    buffer_load_dwordx4 v10, s[32:35], s17 offen offset:2048 lds
    s_add_u32 s17, s47, 95232
    buffer_load_dwordx4 v10, s[32:35], s17 offen offset:3072 lds
    s_waitcnt vmcnt(59)
    s_mov_b32 m0, 159744
    s_add_u32 s47, s46, 15
    s_and_b32 s47, s47, 15
    s_lshl_b32 s47, s47, 18
    s_add_u32 s17, s47, 131072
    buffer_load_dwordx4 v10, s[32:35], s17 offen offset:0 lds
    s_add_u32 s17, s47, 162816
    buffer_load_dwordx4 v10, s[32:35], s17 offen offset:1024 lds
    s_add_u32 s17, s47, 194560
    buffer_load_dwordx4 v10, s[32:35], s17 offen offset:2048 lds
    s_add_u32 s17, s47, 226304
    buffer_load_dwordx4 v10, s[32:35], s17 offen offset:3072 lds
    s_waitcnt vmcnt(48)
    s_barrier
    s_waitcnt vmcnt(59)
    s_mov_b32 m0, 0
    s_mov_b32 s17, 0
    buffer_load_dwordx4 v4, s[24:27], s17 offen offset:0 nt lds
    buffer_load_dwordx4 v5, s[24:27], s17 offen offset:1024 nt lds
    buffer_load_dwordx4 v6, s[24:27], s17 offen offset:2048 nt lds
    buffer_load_dwordx4 v7, s[24:27], s17 offen offset:3072 nt lds
    s_waitcnt vmcnt(59)
    s_mov_b32 m0, 4096
    s_mov_b32 s17, 4096
    buffer_load_dwordx4 v4, s[24:27], s17 offen offset:0 nt lds
    buffer_load_dwordx4 v5, s[24:27], s17 offen offset:1024 nt lds
    buffer_load_dwordx4 v6, s[24:27], s17 offen offset:2048 nt lds
    buffer_load_dwordx4 v7, s[24:27], s17 offen offset:3072 nt lds
    s_waitcnt vmcnt(59)
    s_mov_b32 m0, 8192
    s_mov_b32 s17, 8192
    buffer_load_dwordx4 v4, s[24:27], s17 offen offset:0 nt lds
    buffer_load_dwordx4 v5, s[24:27], s17 offen offset:1024 nt lds
    buffer_load_dwordx4 v6, s[24:27], s17 offen offset:2048 nt lds
    buffer_load_dwordx4 v7, s[24:27], s17 offen offset:3072 nt lds
    s_waitcnt vmcnt(52)
    s_barrier
    s_waitcnt vmcnt(59)
    s_mov_b32 m0, 12288
    s_mov_b32 s17, 12288
    buffer_load_dwordx4 v4, s[24:27], s17 offen offset:0 nt lds
    buffer_load_dwordx4 v5, s[24:27], s17 offen offset:1024 nt lds
    buffer_load_dwordx4 v6, s[24:27], s17 offen offset:2048 nt lds
    buffer_load_dwordx4 v7, s[24:27], s17 offen offset:3072 nt lds
    s_waitcnt vmcnt(59)
    s_mov_b32 m0, 16384
    s_mov_b32 s17, 0
    buffer_load_dwordx4 v8, s[28:31], s17 offen offset:0 nt lds
    buffer_load_dwordx4 v9, s[28:31], s17 offen offset:1024 nt lds
    buffer_load_dwordx4 v8, s[28:31], s17 offen offset:2048 nt lds
    buffer_load_dwordx4 v9, s[28:31], s17 offen offset:3072 nt lds
    s_waitcnt vmcnt(59)
    s_mov_b32 m0, 20480
    s_mov_b32 s17, 4096
    buffer_load_dwordx4 v8, s[28:31], s17 offen offset:0 nt lds
    buffer_load_dwordx4 v9, s[28:31], s17 offen offset:1024 nt lds
    buffer_load_dwordx4 v8, s[28:31], s17 offen offset:2048 nt lds
    buffer_load_dwordx4 v9, s[28:31], s17 offen offset:3072 nt lds
    s_waitcnt vmcnt(56)
    s_barrier
    s_waitcnt vmcnt(59)
    s_mov_b32 m0, 24576
    s_mov_b32 s17, 8192
    buffer_load_dwordx4 v8, s[28:31], s17 offen offset:0 nt lds
    buffer_load_dwordx4 v9, s[28:31], s17 offen offset:1024 nt lds
    buffer_load_dwordx4 v8, s[28:31], s17 offen offset:2048 nt lds
    buffer_load_dwordx4 v9, s[28:31], s17 offen offset:3072 nt lds
    s_waitcnt vmcnt(59)
    s_mov_b32 m0, 28672
    s_mov_b32 s17, 12288
    buffer_load_dwordx4 v8, s[28:31], s17 offen offset:0 nt lds
    buffer_load_dwordx4 v9, s[28:31], s17 offen offset:1024 nt lds
    buffer_load_dwordx4 v8, s[28:31], s17 offen offset:2048 nt lds
    buffer_load_dwordx4 v9, s[28:31], s17 offen offset:3072 nt lds
    s_waitcnt vmcnt(59)
    s_mov_b32 m0, 32768
    s_mov_b32 s17, 16384
    buffer_load_dwordx4 v4, s[24:27], s17 offen offset:0 nt lds
    buffer_load_dwordx4 v5, s[24:27], s17 offen offset:1024 nt lds
    buffer_load_dwordx4 v6, s[24:27], s17 offen offset:2048 nt lds
    buffer_load_dwordx4 v7, s[24:27], s17 offen offset:3072 nt lds
    s_waitcnt vmcnt(60)
    s_barrier
    s_waitcnt vmcnt(59)
    s_mov_b32 m0, 36864
    s_mov_b32 s17, 20480
    buffer_load_dwordx4 v4, s[24:27], s17 offen offset:0 nt lds
    buffer_load_dwordx4 v5, s[24:27], s17 offen offset:1024 nt lds
    buffer_load_dwordx4 v6, s[24:27], s17 offen offset:2048 nt lds
    buffer_load_dwordx4 v7, s[24:27], s17 offen offset:3072 nt lds
    s_waitcnt vmcnt(59)
    s_mov_b32 m0, 40960
    s_mov_b32 s17, 24576
    buffer_load_dwordx4 v4, s[24:27], s17 offen offset:0 nt lds
    buffer_load_dwordx4 v5, s[24:27], s17 offen offset:1024 nt lds
    buffer_load_dwordx4 v6, s[24:27], s17 offen offset:2048 nt lds
    buffer_load_dwordx4 v7, s[24:27], s17 offen offset:3072 nt lds
    s_waitcnt vmcnt(59)
    s_mov_b32 m0, 45056
    s_mov_b32 s17, 28672
    buffer_load_dwordx4 v4, s[24:27], s17 offen offset:0 nt lds
    buffer_load_dwordx4 v5, s[24:27], s17 offen offset:1024 nt lds
    buffer_load_dwordx4 v6, s[24:27], s17 offen offset:2048 nt lds
    buffer_load_dwordx4 v7, s[24:27], s17 offen offset:3072 nt lds
    s_barrier
    s_waitcnt vmcnt(59)
    s_mov_b32 m0, 49152
    s_mov_b32 s17, 16384
    buffer_load_dwordx4 v8, s[28:31], s17 offen offset:0 nt lds
    buffer_load_dwordx4 v9, s[28:31], s17 offen offset:1024 nt lds
    buffer_load_dwordx4 v8, s[28:31], s17 offen offset:2048 nt lds
    buffer_load_dwordx4 v9, s[28:31], s17 offen offset:3072 nt lds
    s_waitcnt vmcnt(59)
    s_mov_b32 m0, 53248
    s_mov_b32 s17, 20480
    buffer_load_dwordx4 v8, s[28:31], s17 offen offset:0 nt lds
    buffer_load_dwordx4 v9, s[28:31], s17 offen offset:1024 nt lds
    buffer_load_dwordx4 v8, s[28:31], s17 offen offset:2048 nt lds
    buffer_load_dwordx4 v9, s[28:31], s17 offen offset:3072 nt lds
    s_waitcnt vmcnt(59)
    s_mov_b32 m0, 57344
    s_mov_b32 s17, 24576
    buffer_load_dwordx4 v8, s[28:31], s17 offen offset:0 nt lds
    buffer_load_dwordx4 v9, s[28:31], s17 offen offset:1024 nt lds
    buffer_load_dwordx4 v8, s[28:31], s17 offen offset:2048 nt lds
    buffer_load_dwordx4 v9, s[28:31], s17 offen offset:3072 nt lds
    s_barrier
    s_waitcnt vmcnt(59)
    s_mov_b32 m0, 61440
    s_mov_b32 s17, 28672
    buffer_load_dwordx4 v8, s[28:31], s17 offen offset:0 nt lds
    buffer_load_dwordx4 v9, s[28:31], s17 offen offset:1024 nt lds
    buffer_load_dwordx4 v8, s[28:31], s17 offen offset:2048 nt lds
    buffer_load_dwordx4 v9, s[28:31], s17 offen offset:3072 nt lds
    s_waitcnt vmcnt(59)
    s_mov_b32 m0, 65536
    s_mov_b32 s17, 32768
    buffer_load_dwordx4 v4, s[24:27], s17 offen offset:0 nt lds
    buffer_load_dwordx4 v5, s[24:27], s17 offen offset:1024 nt lds
    buffer_load_dwordx4 v6, s[24:27], s17 offen offset:2048 nt lds
    buffer_load_dwordx4 v7, s[24:27], s17 offen offset:3072 nt lds
    s_waitcnt vmcnt(59)
    s_mov_b32 m0, 69632
    s_mov_b32 s17, 36864
    buffer_load_dwordx4 v4, s[24:27], s17 offen offset:0 nt lds
    buffer_load_dwordx4 v5, s[24:27], s17 offen offset:1024 nt lds
    buffer_load_dwordx4 v6, s[24:27], s17 offen offset:2048 nt lds
    buffer_load_dwordx4 v7, s[24:27], s17 offen offset:3072 nt lds
    s_barrier
    s_waitcnt vmcnt(59)
    s_mov_b32 m0, 73728
    s_mov_b32 s17, 40960
    buffer_load_dwordx4 v4, s[24:27], s17 offen offset:0 nt lds
    buffer_load_dwordx4 v5, s[24:27], s17 offen offset:1024 nt lds
    buffer_load_dwordx4 v6, s[24:27], s17 offen offset:2048 nt lds
    buffer_load_dwordx4 v7, s[24:27], s17 offen offset:3072 nt lds
    s_waitcnt vmcnt(59)
    s_mov_b32 m0, 77824
    s_mov_b32 s17, 45056
    buffer_load_dwordx4 v4, s[24:27], s17 offen offset:0 nt lds
    buffer_load_dwordx4 v5, s[24:27], s17 offen offset:1024 nt lds
    buffer_load_dwordx4 v6, s[24:27], s17 offen offset:2048 nt lds
    buffer_load_dwordx4 v7, s[24:27], s17 offen offset:3072 nt lds
    s_waitcnt vmcnt(59)
    s_mov_b32 m0, 81920
    s_mov_b32 s17, 32768
    buffer_load_dwordx4 v8, s[28:31], s17 offen offset:0 nt lds
    buffer_load_dwordx4 v9, s[28:31], s17 offen offset:1024 nt lds
    buffer_load_dwordx4 v8, s[28:31], s17 offen offset:2048 nt lds
    buffer_load_dwordx4 v9, s[28:31], s17 offen offset:3072 nt lds
    s_barrier
    s_waitcnt vmcnt(59)
    s_mov_b32 m0, 86016
    s_mov_b32 s17, 36864
    buffer_load_dwordx4 v8, s[28:31], s17 offen offset:0 nt lds
    buffer_load_dwordx4 v9, s[28:31], s17 offen offset:1024 nt lds
    buffer_load_dwordx4 v8, s[28:31], s17 offen offset:2048 nt lds
    buffer_load_dwordx4 v9, s[28:31], s17 offen offset:3072 nt lds
    s_waitcnt vmcnt(59)
    s_mov_b32 m0, 90112
    s_mov_b32 s17, 40960
    buffer_load_dwordx4 v8, s[28:31], s17 offen offset:0 nt lds
    buffer_load_dwordx4 v9, s[28:31], s17 offen offset:1024 nt lds
    buffer_load_dwordx4 v8, s[28:31], s17 offen offset:2048 nt lds
    buffer_load_dwordx4 v9, s[28:31], s17 offen offset:3072 nt lds
    s_waitcnt vmcnt(59)
    s_mov_b32 m0, 94208
    s_mov_b32 s17, 45056
    buffer_load_dwordx4 v8, s[28:31], s17 offen offset:0 nt lds
    buffer_load_dwordx4 v9, s[28:31], s17 offen offset:1024 nt lds
    buffer_load_dwordx4 v8, s[28:31], s17 offen offset:2048 nt lds
    buffer_load_dwordx4 v9, s[28:31], s17 offen offset:3072 nt lds
    s_barrier
    s_mov_b32 s40, 98304
    s_mov_b32 s41, 49152
    s_mov_b32 s42, 3
    s_waitcnt vmcnt(59)
    s_add_u32 m0, s40, 0
    s_add_u32 s17, s41, 0
    buffer_load_dwordx4 v4, s[24:27], s17 offen offset:0 nt lds
    buffer_load_dwordx4 v5, s[24:27], s17 offen offset:1024 nt lds
    buffer_load_dwordx4 v6, s[24:27], s17 offen offset:2048 nt lds
    buffer_load_dwordx4 v7, s[24:27], s17 offen offset:3072 nt lds
    s_waitcnt vmcnt(59)
    s_add_u32 m0, s40, 4096
    s_add_u32 s17, s41, 4096
    buffer_load_dwordx4 v4, s[24:27], s17 offen offset:0 nt lds
    buffer_load_dwordx4 v5, s[24:27], s17 offen offset:1024 nt lds
    buffer_load_dwordx4 v6, s[24:27], s17 offen offset:2048 nt lds
    buffer_load_dwordx4 v7, s[24:27], s17 offen offset:3072 nt lds
    s_waitcnt vmcnt(59)
    s_add_u32 m0, s40, 8192
    s_add_u32 s17, s41, 8192
    buffer_load_dwordx4 v4, s[24:27], s17 offen offset:0 nt lds
    buffer_load_dwordx4 v5, s[24:27], s17 offen offset:1024 nt lds
    buffer_load_dwordx4 v6, s[24:27], s17 offen offset:2048 nt lds
    buffer_load_dwordx4 v7, s[24:27], s17 offen offset:3072 nt lds
    s_waitcnt vmcnt(59)
    s_add_u32 m0, s40, 12288
    s_add_u32 s17, s41, 12288
    buffer_load_dwordx4 v4, s[24:27], s17 offen offset:0 nt lds
    buffer_load_dwordx4 v5, s[24:27], s17 offen offset:1024 nt lds
    buffer_load_dwordx4 v6, s[24:27], s17 offen offset:2048 nt lds
    buffer_load_dwordx4 v7, s[24:27], s17 offen offset:3072 nt lds
    s_waitcnt vmcnt(59)
    s_add_u32 m0, s40, 16384
    s_add_u32 s17, s41, 0
    buffer_load_dwordx4 v8, s[28:31], s17 offen offset:0 nt lds
    buffer_load_dwordx4 v9, s[28:31], s17 offen offset:1024 nt lds
    buffer_load_dwordx4 v8, s[28:31], s17 offen offset:2048 nt lds
    buffer_load_dwordx4 v9, s[28:31], s17 offen offset:3072 nt lds
    s_waitcnt vmcnt(59)
    s_add_u32 m0, s40, 20480
    s_add_u32 s17, s41, 4096
    buffer_load_dwordx4 v8, s[28:31], s17 offen offset:0 nt lds
    buffer_load_dwordx4 v9, s[28:31], s17 offen offset:1024 nt lds
    buffer_load_dwordx4 v8, s[28:31], s17 offen offset:2048 nt lds
    buffer_load_dwordx4 v9, s[28:31], s17 offen offset:3072 nt lds
    s_waitcnt vmcnt(59)
    s_add_u32 m0, s40, 24576
    s_add_u32 s17, s41, 8192
    buffer_load_dwordx4 v8, s[28:31], s17 offen offset:0 nt lds
    buffer_load_dwordx4 v9, s[28:31], s17 offen offset:1024 nt lds
    buffer_load_dwordx4 v8, s[28:31], s17 offen offset:2048 nt lds
    buffer_load_dwordx4 v9, s[28:31], s17 offen offset:3072 nt lds
    s_waitcnt vmcnt(59)
    s_add_u32 m0, s40, 28672
    s_add_u32 s17, s41, 12288
    buffer_load_dwordx4 v8, s[28:31], s17 offen offset:0 nt lds
    buffer_load_dwordx4 v9, s[28:31], s17 offen offset:1024 nt lds
    buffer_load_dwordx4 v8, s[28:31], s17 offen offset:2048 nt lds
    buffer_load_dwordx4 v9, s[28:31], s17 offen offset:3072 nt lds
    s_add_u32 s41, s41, 16384
    s_add_u32 s40, s40, 32768
    s_cmp_eq_u32 s40, 163840
    s_cselect_b32 s40, 0, s40
    s_mov_b32 s42, 4
    s_branch A_LENTRY
A_LLOOP:
    s_barrier
A_LENTRY:
    s_waitcnt vmcnt(59)
    s_add_u32 m0, s40, 0
    s_add_u32 s17, s41, 0
    buffer_load_dwordx4 v4, s[24:27], s17 offen offset:0 nt lds
    buffer_load_dwordx4 v5, s[24:27], s17 offen offset:1024 nt lds
    buffer_load_dwordx4 v6, s[24:27], s17 offen offset:2048 nt lds
    buffer_load_dwordx4 v7, s[24:27], s17 offen offset:3072 nt lds
    s_waitcnt vmcnt(59)
    s_add_u32 m0, s40, 4096
    s_add_u32 s17, s41, 4096
    buffer_load_dwordx4 v4, s[24:27], s17 offen offset:0 nt lds
    buffer_load_dwordx4 v5, s[24:27], s17 offen offset:1024 nt lds
    buffer_load_dwordx4 v6, s[24:27], s17 offen offset:2048 nt lds
    buffer_load_dwordx4 v7, s[24:27], s17 offen offset:3072 nt lds
    s_waitcnt vmcnt(59)
    s_add_u32 m0, s40, 8192
    s_add_u32 s17, s41, 8192
    buffer_load_dwordx4 v4, s[24:27], s17 offen offset:0 nt lds
    buffer_load_dwordx4 v5, s[24:27], s17 offen offset:1024 nt lds
    buffer_load_dwordx4 v6, s[24:27], s17 offen offset:2048 nt lds
    buffer_load_dwordx4 v7, s[24:27], s17 offen offset:3072 nt lds
    s_waitcnt vmcnt(59)
    s_add_u32 m0, s40, 12288
    s_add_u32 s17, s41, 12288
    buffer_load_dwordx4 v4, s[24:27], s17 offen offset:0 nt lds
    buffer_load_dwordx4 v5, s[24:27], s17 offen offset:1024 nt lds
    buffer_load_dwordx4 v6, s[24:27], s17 offen offset:2048 nt lds
    buffer_load_dwordx4 v7, s[24:27], s17 offen offset:3072 nt lds
    s_waitcnt vmcnt(59)
    s_add_u32 m0, s40, 16384
    s_add_u32 s17, s41, 0
    buffer_load_dwordx4 v8, s[28:31], s17 offen offset:0 nt lds
    buffer_load_dwordx4 v9, s[28:31], s17 offen offset:1024 nt lds
    buffer_load_dwordx4 v8, s[28:31], s17 offen offset:2048 nt lds
    buffer_load_dwordx4 v9, s[28:31], s17 offen offset:3072 nt lds
    s_waitcnt vmcnt(59)
    s_add_u32 m0, s40, 20480
    s_add_u32 s17, s41, 4096
    buffer_load_dwordx4 v8, s[28:31], s17 offen offset:0 nt lds
    buffer_load_dwordx4 v9, s[28:31], s17 offen offset:1024 nt lds
    buffer_load_dwordx4 v8, s[28:31], s17 offen offset:2048 nt lds
    buffer_load_dwordx4 v9, s[28:31], s17 offen offset:3072 nt lds
    s_waitcnt vmcnt(59)
    s_add_u32 m0, s40, 24576
    s_add_u32 s17, s41, 8192
    buffer_load_dwordx4 v8, s[28:31], s17 offen offset:0 nt lds
    buffer_load_dwordx4 v9, s[28:31], s17 offen offset:1024 nt lds
    buffer_load_dwordx4 v8, s[28:31], s17 offen offset:2048 nt lds
    buffer_load_dwordx4 v9, s[28:31], s17 offen offset:3072 nt lds
    s_waitcnt vmcnt(59)
    s_add_u32 m0, s40, 28672
    s_add_u32 s17, s41, 12288
    buffer_load_dwordx4 v8, s[28:31], s17 offen offset:0 nt lds
    buffer_load_dwordx4 v9, s[28:31], s17 offen offset:1024 nt lds
    buffer_load_dwordx4 v8, s[28:31], s17 offen offset:2048 nt lds
    buffer_load_dwordx4 v9, s[28:31], s17 offen offset:3072 nt lds
    s_add_u32 s41, s41, 16384
    s_add_u32 s40, s40, 32768
    s_cmp_eq_u32 s40, 163840
    s_cselect_b32 s40, 0, s40
    s_add_u32 s42, s42, 1
    s_cmp_lt_u32 s42, 16
    s_cbranch_scc1 A_LLOOP
    s_barrier
    s_barrier
    s_waitcnt vmcnt(32)
    s_barrier
    s_waitcnt vmcnt(0)
    s_barrier
    s_and_b32 s17, s2, 7
    s_lshl_b32 s17, s17, 19
    s_lshr_b32 s18, s2, 3
    s_lshl_b32 s18, s18, 14
    s_add_u32 s17, s17, s18
    s_add_u32 s80, s84, s17
    s_addc_u32 s81, s85, 0
    s_and_b32 s81, s81, 0xffff
    s_mov_b32 s82, 16384
    s_mov_b32 s83, 0x00020000
    v_lshlrev_b32 v3, 4, v0
    s_mov_b32 s17, 0
    buffer_load_dwordx4 v[16:19], v3, s[80:83], s17 offen
    s_mov_b32 s17, 1024
    buffer_load_dwordx4 v[20:23], v3, s[80:83], s17 offen
    s_mov_b32 s17, 2048
    buffer_load_dwordx4 v[24:27], v3, s[80:83], s17 offen
    s_mov_b32 s17, 3072
    buffer_load_dwordx4 v[28:31], v3, s[80:83], s17 offen
    s_mov_b32 s17, 4096
    buffer_load_dwordx4 v[32:35], v3, s[80:83], s17 offen
    s_mov_b32 s17, 5120
    buffer_load_dwordx4 v[36:39], v3, s[80:83], s17 offen
    s_mov_b32 s17, 6144
    buffer_load_dwordx4 v[40:43], v3, s[80:83], s17 offen
    s_mov_b32 s17, 7168
    buffer_load_dwordx4 v[44:47], v3, s[80:83], s17 offen
    s_mov_b32 s17, 8192
    buffer_load_dwordx4 v[48:51], v3, s[80:83], s17 offen
    s_mov_b32 s17, 9216
    buffer_load_dwordx4 v[52:55], v3, s[80:83], s17 offen
    s_mov_b32 s17, 10240
    buffer_load_dwordx4 v[56:59], v3, s[80:83], s17 offen
    s_mov_b32 s17, 11264
    buffer_load_dwordx4 v[60:63], v3, s[80:83], s17 offen
    s_mov_b32 s17, 12288
    buffer_load_dwordx4 v[64:67], v3, s[80:83], s17 offen
    s_mov_b32 s17, 13312
    buffer_load_dwordx4 v[68:71], v3, s[80:83], s17 offen
    s_mov_b32 s17, 14336
    buffer_load_dwordx4 v[72:75], v3, s[80:83], s17 offen
    s_mov_b32 s17, 15360
    buffer_load_dwordx4 v[76:79], v3, s[80:83], s17 offen
    s_barrier
A_END:
    s_endpgm
.globl oproj_kernel
.p2align 8
.type oproj_kernel,@function
oproj_kernel:
    s_cmp_ge_u32 s2, 256
    s_cbranch_scc1 O_END
    s_load_dwordx2 s[4:5], s[0:1], 32
    s_load_dwordx2 s[8:9], s[0:1], 56
    s_and_b32 s18, s2, 7
    s_lshr_b32 s15, s2, 3
    s_and_b32 s14, s15, 7
    s_lshr_b32 s17, s15, 3
    v_lshrrev_b32 v1, 6, v0
    v_and_b32 v0, 63, v0
    s_nop 0
    v_readfirstlane_b32 s16, v1
    s_waitcnt lgkmcnt(0)
    s_lshl_b32 s19, s18, 19
    s_lshl_b32 s20, s17, 8
    s_add_u32 s19, s19, s20
    s_sub_u32 s20, 524288, s20
    s_add_u32 s24, s4, s19
    s_addc_u32 s25, s5, 0
    s_and_b32 s25, s25, 0xffff
    s_mov_b32 s26, s20
    s_mov_b32 s27, 0x00020000
    s_mul_i32 s19, s14, 1179648
    s_lshl_b32 s20, s18, 14
    s_add_u32 s19, s19, s20
    s_sub_u32 s20, 1179648, s20
    s_add_u32 s28, s8, s19
    s_addc_u32 s29, s9, 0
    s_and_b32 s29, s29, 0xffff
    s_mov_b32 s30, s20
    s_mov_b32 s31, 0x00020000
    s_lshl_b32 s19, s18, 3
    s_add_u32 s19, s19, s14
    s_mul_i32 s19, s19, 36
    s_add_u32 s19, s19, s17
    s_lshl_b32 s19, s19, 13
    s_add_u32 s19, s19, 16777216
    s_lshl_b32 s20, s17, 13
    s_sub_u32 s20, 294912, s20
    s_add_u32 s32, s8, s19
    s_addc_u32 s33, s9, 0
    s_and_b32 s33, s33, 0xffff
    s_mov_b32 s34, s20
    s_mov_b32 s35, 0x00020000
    v_lshrrev_b32 v1, 4, v0
    v_and_b32 v2, 15, v0
    s_lshl_b32 s40, s14, 1
    s_mul_i32 s41, s17, 5
    s_add_u32 s40, s40, s41
    s_cmp_eq_u32 s16, 3
    s_cbranch_scc1 O_LOADER
    s_mul_i32 s19, s16, 393216
    v_lshlrev_b32 v4, 4, v0
    v_add_u32 v4, s19, v4
    v_add_u32 v10, 0x20000, v4
    v_add_u32 v11, 0x40000, v4
    s_add_u32 s41, s40, 0
    s_and_b32 s41, s41, 15
    s_lshl_b32 s43, s41, 10
    buffer_load_dwordx4 a[64:67], v4, s[28:31], s43 offen
    buffer_load_dwordx4 a[68:71], v10, s[28:31], s43 offen
    buffer_load_dwordx4 a[72:75], v11, s[28:31], s43 offen
    s_add_u32 s41, s40, 1
    s_and_b32 s41, s41, 15
    s_lshl_b32 s43, s41, 10
    buffer_load_dwordx4 a[76:79], v4, s[28:31], s43 offen
    buffer_load_dwordx4 a[80:83], v10, s[28:31], s43 offen
    buffer_load_dwordx4 a[84:87], v11, s[28:31], s43 offen
    s_add_u32 s41, s40, 2
    s_and_b32 s41, s41, 15
    s_lshl_b32 s43, s41, 10
    buffer_load_dwordx4 a[88:91], v4, s[28:31], s43 offen
    buffer_load_dwordx4 a[92:95], v10, s[28:31], s43 offen
    buffer_load_dwordx4 a[96:99], v11, s[28:31], s43 offen
    s_add_u32 s41, s40, 3
    s_and_b32 s41, s41, 15
    s_lshl_b32 s43, s41, 10
    buffer_load_dwordx4 a[100:103], v4, s[28:31], s43 offen
    buffer_load_dwordx4 a[104:107], v10, s[28:31], s43 offen
    buffer_load_dwordx4 a[108:111], v11, s[28:31], s43 offen
    s_add_u32 s41, s40, 4
    s_and_b32 s41, s41, 15
    s_lshl_b32 s43, s41, 10
    buffer_load_dwordx4 a[112:115], v4, s[28:31], s43 offen
    buffer_load_dwordx4 a[116:119], v10, s[28:31], s43 offen
    buffer_load_dwordx4 a[120:123], v11, s[28:31], s43 offen
    s_add_u32 s41, s40, 5
    s_and_b32 s41, s41, 15
    s_lshl_b32 s43, s41, 10
    buffer_load_dwordx4 a[124:127], v4, s[28:31], s43 offen
    buffer_load_dwordx4 a[128:131], v10, s[28:31], s43 offen
    buffer_load_dwordx4 a[132:135], v11, s[28:31], s43 offen
    v_lshrrev_b32 v5, 2, v2
    v_and_b32 v6, 3, v2
    v_lshl_add_u32 v7, v1, 3, v5
    v_lshlrev_b32 v7, 8, v7
    v_lshl_add_u32 v7, v6, 6, v7
    v_xor_b32 v9, 0, v5
    v_lshl_add_u32 v56, v9, 4, v7
    v_xor_b32 v9, 1, v5
    v_lshl_add_u32 v57, v9, 4, v7
    v_xor_b32 v9, 2, v5
    v_lshl_add_u32 v58, v9, 4, v7
    v_xor_b32 v9, 3, v5
    v_lshl_add_u32 v59, v9, 4, v7
    v_mov_b32 v64, 0
    v_mov_b32 v65, 0
    v_mov_b32 v66, 0
    v_mov_b32 v67, 0
    v_mov_b32 v68, 0
    v_mov_b32 v69, 0
    v_mov_b32 v70, 0
    v_mov_b32 v71, 0
    v_mov_b32 v72, 0
    v_mov_b32 v73, 0
    v_mov_b32 v74, 0
    v_mov_b32 v75, 0
    v_mov_b32 v76, 0
    v_mov_b32 v77, 0
    v_mov_b32 v78, 0
    v_mov_b32 v79, 0
    v_mov_b32 v80, 0
    v_mov_b32 v81, 0
    v_mov_b32 v82, 0
    v_mov_b32 v83, 0
    v_mov_b32 v84, 0
    v_mov_b32 v85, 0
    v_mov_b32 v86, 0
    v_mov_b32 v87, 0
    v_mov_b32 v88, 0
    v_mov_b32 v89, 0
    v_mov_b32 v90, 0
    v_mov_b32 v91, 0
    v_mov_b32 v92, 0
    v_mov_b32 v93, 0
    v_mov_b32 v94, 0
    v_mov_b32 v95, 0
    v_mov_b32 v96, 0
    v_mov_b32 v97, 0
    v_mov_b32 v98, 0
    v_mov_b32 v99, 0
    v_mov_b32 v100, 0
    v_mov_b32 v101, 0
    v_mov_b32 v102, 0
    v_mov_b32 v103, 0
    v_mov_b32 v104, 0
    v_mov_b32 v105, 0
    v_mov_b32 v106, 0
    v_mov_b32 v107, 0
    v_mov_b32 v108, 0
    v_mov_b32 v109, 0
    v_mov_b32 v110, 0
    v_mov_b32 v111, 0
    v_mov_b32 v112, 0
    v_mov_b32 v113, 0
    v_mov_b32 v114, 0
    v_mov_b32 v115, 0
    v_mov_b32 v116, 0
    v_mov_b32 v117, 0
    v_mov_b32 v118, 0
    v_mov_b32 v119, 0
    v_mov_b32 v120, 0
    v_mov_b32 v121, 0
    v_mov_b32 v122, 0
    v_mov_b32 v123, 0
    v_mov_b32 v124, 0
    v_mov_b32 v125, 0
    v_mov_b32 v126, 0
    v_mov_b32 v127, 0
    v_mov_b32 v128, 0
    v_mov_b32 v129, 0
    v_mov_b32 v130, 0
    v_mov_b32 v131, 0
    v_mov_b32 v132, 0
    v_mov_b32 v133, 0
    v_mov_b32 v134, 0
    v_mov_b32 v135, 0
    v_mov_b32 v136, 0
    v_mov_b32 v137, 0
    v_mov_b32 v138, 0
    v_mov_b32 v139, 0
    v_mov_b32 v140, 0
    v_mov_b32 v141, 0
    v_mov_b32 v142, 0
    v_mov_b32 v143, 0
    v_mov_b32 v144, 0
    v_mov_b32 v145, 0
    v_mov_b32 v146, 0
    v_mov_b32 v147, 0
    v_mov_b32 v148, 0
    v_mov_b32 v149, 0
    v_mov_b32 v150, 0
    v_mov_b32 v151, 0
    v_mov_b32 v152, 0
    v_mov_b32 v153, 0
    v_mov_b32 v154, 0
    v_mov_b32 v155, 0
    v_mov_b32 v156, 0
    v_mov_b32 v157, 0
    v_mov_b32 v158, 0
    v_mov_b32 v159, 0
    v_add_u32 v60, 0x10000, v56
    v_add_u32 v61, 0x10000, v57
    v_add_u32 v62, 0x10000, v58
    v_add_u32 v63, 0x10000, v59
    s_barrier
    ds_read_b64_tr_b16 a[0:1], v56 offset:0
    ds_read_b64_tr_b16 a[2:3], v56 offset:1024
    ds_read_b64_tr_b16 a[4:5], v56 offset:8
    ds_read_b64_tr_b16 a[6:7], v56 offset:1032
    ds_read_b64_tr_b16 a[8:9], v57 offset:0
    ds_read_b64_tr_b16 a[10:11], v57 offset:1024
    ds_read_b64_tr_b16 a[12:13], v57 offset:8
    ds_read_b64_tr_b16 a[14:15], v57 offset:1032
    ds_read_b64_tr_b16 a[16:17], v58 offset:0
    ds_read_b64_tr_b16 a[18:19], v58 offset:1024
    ds_read_b64_tr_b16 a[20:21], v58 offset:8
    ds_read_b64_tr_b16 a[22:23], v58 offset:1032
    ds_read_b64_tr_b16 a[24:25], v59 offset:0
    ds_read_b64_tr_b16 a[26:27], v59 offset:1024
    ds_read_b64_tr_b16 a[28:29], v59 offset:8
    ds_read_b64_tr_b16 a[30:31], v59 offset:1032
    s_waitcnt lgkmcnt(0) vmcnt(15)
    v_mfma_f32_16x16x32_bf16 v[64:67], a[0:3], a[64:67], v[64:67]
    ds_read_b64_tr_b16 a[32:33], v56 offset:8192
    v_mfma_f32_16x16x32_bf16 v[96:99], a[0:3], a[68:71], v[96:99]
    ds_read_b64_tr_b16 a[34:35], v56 offset:9216
    v_mfma_f32_16x16x32_bf16 v[128:131], a[0:3], a[72:75], v[128:131]
    ds_read_b64_tr_b16 a[36:37], v56 offset:8200
    v_mfma_f32_16x16x32_bf16 v[68:71], a[4:7], a[64:67], v[68:71]
    ds_read_b64_tr_b16 a[38:39], v56 offset:9224
    v_mfma_f32_16x16x32_bf16 v[100:103], a[4:7], a[68:71], v[100:103]
    ds_read_b64_tr_b16 a[40:41], v57 offset:8192
    v_mfma_f32_16x16x32_bf16 v[132:135], a[4:7], a[72:75], v[132:135]
    ds_read_b64_tr_b16 a[42:43], v57 offset:9216
    v_mfma_f32_16x16x32_bf16 v[72:75], a[8:11], a[64:67], v[72:75]
    ds_read_b64_tr_b16 a[44:45], v57 offset:8200
    v_mfma_f32_16x16x32_bf16 v[104:107], a[8:11], a[68:71], v[104:107]
    ds_read_b64_tr_b16 a[46:47], v57 offset:9224
    v_mfma_f32_16x16x32_bf16 v[136:139], a[8:11], a[72:75], v[136:139]
    ds_read_b64_tr_b16 a[48:49], v58 offset:8192
    v_mfma_f32_16x16x32_bf16 v[76:79], a[12:15], a[64:67], v[76:79]
    ds_read_b64_tr_b16 a[50:51], v58 offset:9216
    v_mfma_f32_16x16x32_bf16 v[108:111], a[12:15], a[68:71], v[108:111]
    ds_read_b64_tr_b16 a[52:53], v58 offset:8200
    v_mfma_f32_16x16x32_bf16 v[140:143], a[12:15], a[72:75], v[140:143]
    ds_read_b64_tr_b16 a[54:55], v58 offset:9224
    v_mfma_f32_16x16x32_bf16 v[80:83], a[16:19], a[64:67], v[80:83]
    ds_read_b64_tr_b16 a[56:57], v59 offset:8192
    v_mfma_f32_16x16x32_bf16 v[112:115], a[16:19], a[68:71], v[112:115]
    ds_read_b64_tr_b16 a[58:59], v59 offset:9216
    v_mfma_f32_16x16x32_bf16 v[144:147], a[16:19], a[72:75], v[144:147]
    ds_read_b64_tr_b16 a[60:61], v59 offset:8200
    s_add_u32 s41, s40, 6
    v_mfma_f32_16x16x32_bf16 v[84:87], a[20:23], a[64:67], v[84:87]
    ds_read_b64_tr_b16 a[62:63], v59 offset:9224
    s_and_b32 s41, s41, 15
    s_lshl_b32 s43, s41, 10
    v_mfma_f32_16x16x32_bf16 v[116:119], a[20:23], a[68:71], v[116:119]
    v_mfma_f32_16x16x32_bf16 v[148:151], a[20:23], a[72:75], v[148:151]
    buffer_load_dwordx4 a[136:139], v4, s[28:31], s43 offen
    v_mfma_f32_16x16x32_bf16 v[88:91], a[24:27], a[64:67], v[88:91]
    v_mfma_f32_16x16x32_bf16 v[120:123], a[24:27], a[68:71], v[120:123]
    v_mfma_f32_16x16x32_bf16 v[152:155], a[24:27], a[72:75], v[152:155]
    buffer_load_dwordx4 a[140:143], v10, s[28:31], s43 offen
    v_mfma_f32_16x16x32_bf16 v[92:95], a[28:31], a[64:67], v[92:95]
    v_mfma_f32_16x16x32_bf16 v[124:127], a[28:31], a[68:71], v[124:127]
    buffer_load_dwordx4 a[144:147], v11, s[28:31], s43 offen
    v_mfma_f32_16x16x32_bf16 v[156:159], a[28:31], a[72:75], v[156:159]
    s_waitcnt lgkmcnt(0) vmcnt(15)
    s_barrier
    v_mfma_f32_16x16x32_bf16 v[64:67], a[32:35], a[76:79], v[64:67]
    ds_read_b64_tr_b16 a[0:1], v56 offset:16384
    v_mfma_f32_16x16x32_bf16 v[96:99], a[32:35], a[80:83], v[96:99]
    ds_read_b64_tr_b16 a[2:3], v56 offset:17408
    v_mfma_f32_16x16x32_bf16 v[128:131], a[32:35], a[84:87], v[128:131]
    ds_read_b64_tr_b16 a[4:5], v56 offset:16392
    v_mfma_f32_16x16x32_bf16 v[68:71], a[36:39], a[76:79], v[68:71]
    ds_read_b64_tr_b16 a[6:7], v56 offset:17416
    v_mfma_f32_16x16x32_bf16 v[100:103], a[36:39], a[80:83], v[100:103]
    ds_read_b64_tr_b16 a[8:9], v57 offset:16384
    v_mfma_f32_16x16x32_bf16 v[132:135], a[36:39], a[84:87], v[132:135]
    ds_read_b64_tr_b16 a[10:11], v57 offset:17408
    v_mfma_f32_16x16x32_bf16 v[72:75], a[40:43], a[76:79], v[72:75]
    ds_read_b64_tr_b16 a[12:13], v57 offset:16392
    v_mfma_f32_16x16x32_bf16 v[104:107], a[40:43], a[80:83], v[104:107]
    ds_read_b64_tr_b16 a[14:15], v57 offset:17416
    v_mfma_f32_16x16x32_bf16 v[136:139], a[40:43], a[84:87], v[136:139]
    ds_read_b64_tr_b16 a[16:17], v58 offset:16384
    v_mfma_f32_16x16x32_bf16 v[76:79], a[44:47], a[76:79], v[76:79]
    ds_read_b64_tr_b16 a[18:19], v58 offset:17408
    v_mfma_f32_16x16x32_bf16 v[108:111], a[44:47], a[80:83], v[108:111]
    ds_read_b64_tr_b16 a[20:21], v58 offset:16392
    v_mfma_f32_16x16x32_bf16 v[140:143], a[44:47], a[84:87], v[140:143]
    ds_read_b64_tr_b16 a[22:23], v58 offset:17416
    v_mfma_f32_16x16x32_bf16 v[80:83], a[48:51], a[76:79], v[80:83]
    ds_read_b64_tr_b16 a[24:25], v59 offset:16384
    v_mfma_f32_16x16x32_bf16 v[112:115], a[48:51], a[80:83], v[112:115]
    ds_read_b64_tr_b16 a[26:27], v59 offset:17408
    v_mfma_f32_16x16x32_bf16 v[144:147], a[48:51], a[84:87], v[144:147]
    ds_read_b64_tr_b16 a[28:29], v59 offset:16392
    s_add_u32 s41, s40, 7
    v_mfma_f32_16x16x32_bf16 v[84:87], a[52:55], a[76:79], v[84:87]
    ds_read_b64_tr_b16 a[30:31], v59 offset:17416
    s_and_b32 s41, s41, 15
    s_lshl_b32 s43, s41, 10
    v_mfma_f32_16x16x32_bf16 v[116:119], a[52:55], a[80:83], v[116:119]
    v_mfma_f32_16x16x32_bf16 v[148:151], a[52:55], a[84:87], v[148:151]
    buffer_load_dwordx4 a[148:151], v4, s[28:31], s43 offen
    v_mfma_f32_16x16x32_bf16 v[88:91], a[56:59], a[76:79], v[88:91]
    v_mfma_f32_16x16x32_bf16 v[120:123], a[56:59], a[80:83], v[120:123]
    v_mfma_f32_16x16x32_bf16 v[152:155], a[56:59], a[84:87], v[152:155]
    buffer_load_dwordx4 a[152:155], v10, s[28:31], s43 offen
    v_mfma_f32_16x16x32_bf16 v[92:95], a[60:63], a[76:79], v[92:95]
    v_mfma_f32_16x16x32_bf16 v[124:127], a[60:63], a[80:83], v[124:127]
    buffer_load_dwordx4 a[156:159], v11, s[28:31], s43 offen
    v_mfma_f32_16x16x32_bf16 v[156:159], a[60:63], a[84:87], v[156:159]
    s_waitcnt lgkmcnt(0) vmcnt(15)
    v_mfma_f32_16x16x32_bf16 v[64:67], a[0:3], a[88:91], v[64:67]
    ds_read_b64_tr_b16 a[32:33], v56 offset:24576
    v_mfma_f32_16x16x32_bf16 v[96:99], a[0:3], a[92:95], v[96:99]
    ds_read_b64_tr_b16 a[34:35], v56 offset:25600
    v_mfma_f32_16x16x32_bf16 v[128:131], a[0:3], a[96:99], v[128:131]
    ds_read_b64_tr_b16 a[36:37], v56 offset:24584
    v_mfma_f32_16x16x32_bf16 v[68:71], a[4:7], a[88:91], v[68:71]
    ds_read_b64_tr_b16 a[38:39], v56 offset:25608
    v_mfma_f32_16x16x32_bf16 v[100:103], a[4:7], a[92:95], v[100:103]
    ds_read_b64_tr_b16 a[40:41], v57 offset:24576
    v_mfma_f32_16x16x32_bf16 v[132:135], a[4:7], a[96:99], v[132:135]
    ds_read_b64_tr_b16 a[42:43], v57 offset:25600
    v_mfma_f32_16x16x32_bf16 v[72:75], a[8:11], a[88:91], v[72:75]
    ds_read_b64_tr_b16 a[44:45], v57 offset:24584
    v_mfma_f32_16x16x32_bf16 v[104:107], a[8:11], a[92:95], v[104:107]
    ds_read_b64_tr_b16 a[46:47], v57 offset:25608
    v_mfma_f32_16x16x32_bf16 v[136:139], a[8:11], a[96:99], v[136:139]
    ds_read_b64_tr_b16 a[48:49], v58 offset:24576
    v_mfma_f32_16x16x32_bf16 v[76:79], a[12:15], a[88:91], v[76:79]
    ds_read_b64_tr_b16 a[50:51], v58 offset:25600
    v_mfma_f32_16x16x32_bf16 v[108:111], a[12:15], a[92:95], v[108:111]
    ds_read_b64_tr_b16 a[52:53], v58 offset:24584
    v_mfma_f32_16x16x32_bf16 v[140:143], a[12:15], a[96:99], v[140:143]
    ds_read_b64_tr_b16 a[54:55], v58 offset:25608
    v_mfma_f32_16x16x32_bf16 v[80:83], a[16:19], a[88:91], v[80:83]
    ds_read_b64_tr_b16 a[56:57], v59 offset:24576
    v_mfma_f32_16x16x32_bf16 v[112:115], a[16:19], a[92:95], v[112:115]
    ds_read_b64_tr_b16 a[58:59], v59 offset:25600
    v_mfma_f32_16x16x32_bf16 v[144:147], a[16:19], a[96:99], v[144:147]
    ds_read_b64_tr_b16 a[60:61], v59 offset:24584
    s_add_u32 s41, s40, 8
    v_mfma_f32_16x16x32_bf16 v[84:87], a[20:23], a[88:91], v[84:87]
    ds_read_b64_tr_b16 a[62:63], v59 offset:25608
    s_and_b32 s41, s41, 15
    s_lshl_b32 s43, s41, 10
    v_mfma_f32_16x16x32_bf16 v[116:119], a[20:23], a[92:95], v[116:119]
    v_mfma_f32_16x16x32_bf16 v[148:151], a[20:23], a[96:99], v[148:151]
    buffer_load_dwordx4 a[160:163], v4, s[28:31], s43 offen
    v_mfma_f32_16x16x32_bf16 v[88:91], a[24:27], a[88:91], v[88:91]
    v_mfma_f32_16x16x32_bf16 v[120:123], a[24:27], a[92:95], v[120:123]
    v_mfma_f32_16x16x32_bf16 v[152:155], a[24:27], a[96:99], v[152:155]
    buffer_load_dwordx4 a[164:167], v10, s[28:31], s43 offen
    v_mfma_f32_16x16x32_bf16 v[92:95], a[28:31], a[88:91], v[92:95]
    v_mfma_f32_16x16x32_bf16 v[124:127], a[28:31], a[92:95], v[124:127]
    buffer_load_dwordx4 a[168:171], v11, s[28:31], s43 offen
    v_mfma_f32_16x16x32_bf16 v[156:159], a[28:31], a[96:99], v[156:159]
    s_waitcnt lgkmcnt(0) vmcnt(15)
    s_barrier
    v_mfma_f32_16x16x32_bf16 v[64:67], a[32:35], a[100:103], v[64:67]
    ds_read_b64_tr_b16 a[0:1], v56 offset:32768
    v_mfma_f32_16x16x32_bf16 v[96:99], a[32:35], a[104:107], v[96:99]
    ds_read_b64_tr_b16 a[2:3], v56 offset:33792
    v_mfma_f32_16x16x32_bf16 v[128:131], a[32:35], a[108:111], v[128:131]
    ds_read_b64_tr_b16 a[4:5], v56 offset:32776
    v_mfma_f32_16x16x32_bf16 v[68:71], a[36:39], a[100:103], v[68:71]
    ds_read_b64_tr_b16 a[6:7], v56 offset:33800
    v_mfma_f32_16x16x32_bf16 v[100:103], a[36:39], a[104:107], v[100:103]
    ds_read_b64_tr_b16 a[8:9], v57 offset:32768
    v_mfma_f32_16x16x32_bf16 v[132:135], a[36:39], a[108:111], v[132:135]
    ds_read_b64_tr_b16 a[10:11], v57 offset:33792
    v_mfma_f32_16x16x32_bf16 v[72:75], a[40:43], a[100:103], v[72:75]
    ds_read_b64_tr_b16 a[12:13], v57 offset:32776
    v_mfma_f32_16x16x32_bf16 v[104:107], a[40:43], a[104:107], v[104:107]
    ds_read_b64_tr_b16 a[14:15], v57 offset:33800
    v_mfma_f32_16x16x32_bf16 v[136:139], a[40:43], a[108:111], v[136:139]
    ds_read_b64_tr_b16 a[16:17], v58 offset:32768
    v_mfma_f32_16x16x32_bf16 v[76:79], a[44:47], a[100:103], v[76:79]
    ds_read_b64_tr_b16 a[18:19], v58 offset:33792
    v_mfma_f32_16x16x32_bf16 v[108:111], a[44:47], a[104:107], v[108:111]
    ds_read_b64_tr_b16 a[20:21], v58 offset:32776
    v_mfma_f32_16x16x32_bf16 v[140:143], a[44:47], a[108:111], v[140:143]
    ds_read_b64_tr_b16 a[22:23], v58 offset:33800
    v_mfma_f32_16x16x32_bf16 v[80:83], a[48:51], a[100:103], v[80:83]
    ds_read_b64_tr_b16 a[24:25], v59 offset:32768
    v_mfma_f32_16x16x32_bf16 v[112:115], a[48:51], a[104:107], v[112:115]
    ds_read_b64_tr_b16 a[26:27], v59 offset:33792
    v_mfma_f32_16x16x32_bf16 v[144:147], a[48:51], a[108:111], v[144:147]
    ds_read_b64_tr_b16 a[28:29], v59 offset:32776
    s_add_u32 s41, s40, 9
    v_mfma_f32_16x16x32_bf16 v[84:87], a[52:55], a[100:103], v[84:87]
    ds_read_b64_tr_b16 a[30:31], v59 offset:33800
    s_and_b32 s41, s41, 15
    s_lshl_b32 s43, s41, 10
    v_mfma_f32_16x16x32_bf16 v[116:119], a[52:55], a[104:107], v[116:119]
    v_mfma_f32_16x16x32_bf16 v[148:151], a[52:55], a[108:111], v[148:151]
    buffer_load_dwordx4 a[172:175], v4, s[28:31], s43 offen
    v_mfma_f32_16x16x32_bf16 v[88:91], a[56:59], a[100:103], v[88:91]
    v_mfma_f32_16x16x32_bf16 v[120:123], a[56:59], a[104:107], v[120:123]
    v_mfma_f32_16x16x32_bf16 v[152:155], a[56:59], a[108:111], v[152:155]
    buffer_load_dwordx4 a[176:179], v10, s[28:31], s43 offen
    v_mfma_f32_16x16x32_bf16 v[92:95], a[60:63], a[100:103], v[92:95]
    v_mfma_f32_16x16x32_bf16 v[124:127], a[60:63], a[104:107], v[124:127]
    buffer_load_dwordx4 a[180:183], v11, s[28:31], s43 offen
    v_mfma_f32_16x16x32_bf16 v[156:159], a[60:63], a[108:111], v[156:159]
    s_waitcnt lgkmcnt(0) vmcnt(15)
    v_mfma_f32_16x16x32_bf16 v[64:67], a[0:3], a[112:115], v[64:67]
    ds_read_b64_tr_b16 a[32:33], v56 offset:40960
    v_mfma_f32_16x16x32_bf16 v[96:99], a[0:3], a[116:119], v[96:99]
    ds_read_b64_tr_b16 a[34:35], v56 offset:41984
    v_mfma_f32_16x16x32_bf16 v[128:131], a[0:3], a[120:123], v[128:131]
    ds_read_b64_tr_b16 a[36:37], v56 offset:40968
    v_mfma_f32_16x16x32_bf16 v[68:71], a[4:7], a[112:115], v[68:71]
    ds_read_b64_tr_b16 a[38:39], v56 offset:41992
    v_mfma_f32_16x16x32_bf16 v[100:103], a[4:7], a[116:119], v[100:103]
    ds_read_b64_tr_b16 a[40:41], v57 offset:40960
    v_mfma_f32_16x16x32_bf16 v[132:135], a[4:7], a[120:123], v[132:135]
    ds_read_b64_tr_b16 a[42:43], v57 offset:41984
    v_mfma_f32_16x16x32_bf16 v[72:75], a[8:11], a[112:115], v[72:75]
    ds_read_b64_tr_b16 a[44:45], v57 offset:40968
    v_mfma_f32_16x16x32_bf16 v[104:107], a[8:11], a[116:119], v[104:107]
    ds_read_b64_tr_b16 a[46:47], v57 offset:41992
    v_mfma_f32_16x16x32_bf16 v[136:139], a[8:11], a[120:123], v[136:139]
    ds_read_b64_tr_b16 a[48:49], v58 offset:40960
    v_mfma_f32_16x16x32_bf16 v[76:79], a[12:15], a[112:115], v[76:79]
    ds_read_b64_tr_b16 a[50:51], v58 offset:41984
    v_mfma_f32_16x16x32_bf16 v[108:111], a[12:15], a[116:119], v[108:111]
    ds_read_b64_tr_b16 a[52:53], v58 offset:40968
    v_mfma_f32_16x16x32_bf16 v[140:143], a[12:15], a[120:123], v[140:143]
    ds_read_b64_tr_b16 a[54:55], v58 offset:41992
    v_mfma_f32_16x16x32_bf16 v[80:83], a[16:19], a[112:115], v[80:83]
    ds_read_b64_tr_b16 a[56:57], v59 offset:40960
    v_mfma_f32_16x16x32_bf16 v[112:115], a[16:19], a[116:119], v[112:115]
    ds_read_b64_tr_b16 a[58:59], v59 offset:41984
    v_mfma_f32_16x16x32_bf16 v[144:147], a[16:19], a[120:123], v[144:147]
    ds_read_b64_tr_b16 a[60:61], v59 offset:40968
    s_add_u32 s41, s40, 10
    v_mfma_f32_16x16x32_bf16 v[84:87], a[20:23], a[112:115], v[84:87]
    ds_read_b64_tr_b16 a[62:63], v59 offset:41992
    s_and_b32 s41, s41, 15
    s_lshl_b32 s43, s41, 10
    v_mfma_f32_16x16x32_bf16 v[116:119], a[20:23], a[116:119], v[116:119]
    v_mfma_f32_16x16x32_bf16 v[148:151], a[20:23], a[120:123], v[148:151]
    buffer_load_dwordx4 a[184:187], v4, s[28:31], s43 offen
    v_mfma_f32_16x16x32_bf16 v[88:91], a[24:27], a[112:115], v[88:91]
    v_mfma_f32_16x16x32_bf16 v[120:123], a[24:27], a[116:119], v[120:123]
    v_mfma_f32_16x16x32_bf16 v[152:155], a[24:27], a[120:123], v[152:155]
    buffer_load_dwordx4 a[188:191], v10, s[28:31], s43 offen
    v_mfma_f32_16x16x32_bf16 v[92:95], a[28:31], a[112:115], v[92:95]
    v_mfma_f32_16x16x32_bf16 v[124:127], a[28:31], a[116:119], v[124:127]
    buffer_load_dwordx4 a[192:195], v11, s[28:31], s43 offen
    v_mfma_f32_16x16x32_bf16 v[156:159], a[28:31], a[120:123], v[156:159]
    s_waitcnt lgkmcnt(0) vmcnt(15)
    s_barrier
    v_mfma_f32_16x16x32_bf16 v[64:67], a[32:35], a[124:127], v[64:67]
    ds_read_b64_tr_b16 a[0:1], v56 offset:49152
    v_mfma_f32_16x16x32_bf16 v[96:99], a[32:35], a[128:131], v[96:99]
    ds_read_b64_tr_b16 a[2:3], v56 offset:50176
    v_mfma_f32_16x16x32_bf16 v[128:131], a[32:35], a[132:135], v[128:131]
    ds_read_b64_tr_b16 a[4:5], v56 offset:49160
    v_mfma_f32_16x16x32_bf16 v[68:71], a[36:39], a[124:127], v[68:71]
    ds_read_b64_tr_b16 a[6:7], v56 offset:50184
    v_mfma_f32_16x16x32_bf16 v[100:103], a[36:39], a[128:131], v[100:103]
    ds_read_b64_tr_b16 a[8:9], v57 offset:49152
    v_mfma_f32_16x16x32_bf16 v[132:135], a[36:39], a[132:135], v[132:135]
    ds_read_b64_tr_b16 a[10:11], v57 offset:50176
    v_mfma_f32_16x16x32_bf16 v[72:75], a[40:43], a[124:127], v[72:75]
    ds_read_b64_tr_b16 a[12:13], v57 offset:49160
    v_mfma_f32_16x16x32_bf16 v[104:107], a[40:43], a[128:131], v[104:107]
    ds_read_b64_tr_b16 a[14:15], v57 offset:50184
    v_mfma_f32_16x16x32_bf16 v[136:139], a[40:43], a[132:135], v[136:139]
    ds_read_b64_tr_b16 a[16:17], v58 offset:49152
    v_mfma_f32_16x16x32_bf16 v[76:79], a[44:47], a[124:127], v[76:79]
    ds_read_b64_tr_b16 a[18:19], v58 offset:50176
    v_mfma_f32_16x16x32_bf16 v[108:111], a[44:47], a[128:131], v[108:111]
    ds_read_b64_tr_b16 a[20:21], v58 offset:49160
    v_mfma_f32_16x16x32_bf16 v[140:143], a[44:47], a[132:135], v[140:143]
    ds_read_b64_tr_b16 a[22:23], v58 offset:50184
    v_mfma_f32_16x16x32_bf16 v[80:83], a[48:51], a[124:127], v[80:83]
    ds_read_b64_tr_b16 a[24:25], v59 offset:49152
    v_mfma_f32_16x16x32_bf16 v[112:115], a[48:51], a[128:131], v[112:115]
    ds_read_b64_tr_b16 a[26:27], v59 offset:50176
    v_mfma_f32_16x16x32_bf16 v[144:147], a[48:51], a[132:135], v[144:147]
    ds_read_b64_tr_b16 a[28:29], v59 offset:49160
    s_add_u32 s41, s40, 11
    v_mfma_f32_16x16x32_bf16 v[84:87], a[52:55], a[124:127], v[84:87]
    ds_read_b64_tr_b16 a[30:31], v59 offset:50184
    s_and_b32 s41, s41, 15
    s_lshl_b32 s43, s41, 10
    v_mfma_f32_16x16x32_bf16 v[116:119], a[52:55], a[128:131], v[116:119]
    v_mfma_f32_16x16x32_bf16 v[148:151], a[52:55], a[132:135], v[148:151]
    buffer_load_dwordx4 a[196:199], v4, s[28:31], s43 offen
    v_mfma_f32_16x16x32_bf16 v[88:91], a[56:59], a[124:127], v[88:91]
    v_mfma_f32_16x16x32_bf16 v[120:123], a[56:59], a[128:131], v[120:123]
    v_mfma_f32_16x16x32_bf16 v[152:155], a[56:59], a[132:135], v[152:155]
    buffer_load_dwordx4 a[200:203], v10, s[28:31], s43 offen
    v_mfma_f32_16x16x32_bf16 v[92:95], a[60:63], a[124:127], v[92:95]
    v_mfma_f32_16x16x32_bf16 v[124:127], a[60:63], a[128:131], v[124:127]
    buffer_load_dwordx4 a[204:207], v11, s[28:31], s43 offen
    v_mfma_f32_16x16x32_bf16 v[156:159], a[60:63], a[132:135], v[156:159]
    s_waitcnt lgkmcnt(0) vmcnt(15)
    v_mfma_f32_16x16x32_bf16 v[64:67], a[0:3], a[136:139], v[64:67]
    ds_read_b64_tr_b16 a[32:33], v56 offset:57344
    v_mfma_f32_16x16x32_bf16 v[96:99], a[0:3], a[140:143], v[96:99]
    ds_read_b64_tr_b16 a[34:35], v56 offset:58368
    v_mfma_f32_16x16x32_bf16 v[128:131], a[0:3], a[144:147], v[128:131]
    ds_read_b64_tr_b16 a[36:37], v56 offset:57352
    v_mfma_f32_16x16x32_bf16 v[68:71], a[4:7], a[136:139], v[68:71]
    ds_read_b64_tr_b16 a[38:39], v56 offset:58376
    v_mfma_f32_16x16x32_bf16 v[100:103], a[4:7], a[140:143], v[100:103]
    ds_read_b64_tr_b16 a[40:41], v57 offset:57344
    v_mfma_f32_16x16x32_bf16 v[132:135], a[4:7], a[144:147], v[132:135]
    ds_read_b64_tr_b16 a[42:43], v57 offset:58368
    v_mfma_f32_16x16x32_bf16 v[72:75], a[8:11], a[136:139], v[72:75]
    ds_read_b64_tr_b16 a[44:45], v57 offset:57352
    v_mfma_f32_16x16x32_bf16 v[104:107], a[8:11], a[140:143], v[104:107]
    ds_read_b64_tr_b16 a[46:47], v57 offset:58376
    v_mfma_f32_16x16x32_bf16 v[136:139], a[8:11], a[144:147], v[136:139]
    ds_read_b64_tr_b16 a[48:49], v58 offset:57344
    v_mfma_f32_16x16x32_bf16 v[76:79], a[12:15], a[136:139], v[76:79]
    ds_read_b64_tr_b16 a[50:51], v58 offset:58368
    v_mfma_f32_16x16x32_bf16 v[108:111], a[12:15], a[140:143], v[108:111]
    ds_read_b64_tr_b16 a[52:53], v58 offset:57352
    v_mfma_f32_16x16x32_bf16 v[140:143], a[12:15], a[144:147], v[140:143]
    ds_read_b64_tr_b16 a[54:55], v58 offset:58376
    v_mfma_f32_16x16x32_bf16 v[80:83], a[16:19], a[136:139], v[80:83]
    ds_read_b64_tr_b16 a[56:57], v59 offset:57344
    v_mfma_f32_16x16x32_bf16 v[112:115], a[16:19], a[140:143], v[112:115]
    ds_read_b64_tr_b16 a[58:59], v59 offset:58368
    v_mfma_f32_16x16x32_bf16 v[144:147], a[16:19], a[144:147], v[144:147]
    ds_read_b64_tr_b16 a[60:61], v59 offset:57352
    s_add_u32 s41, s40, 12
    v_mfma_f32_16x16x32_bf16 v[84:87], a[20:23], a[136:139], v[84:87]
    ds_read_b64_tr_b16 a[62:63], v59 offset:58376
    s_and_b32 s41, s41, 15
    s_lshl_b32 s43, s41, 10
    v_mfma_f32_16x16x32_bf16 v[116:119], a[20:23], a[140:143], v[116:119]
    v_mfma_f32_16x16x32_bf16 v[148:151], a[20:23], a[144:147], v[148:151]
    buffer_load_dwordx4 a[208:211], v4, s[28:31], s43 offen
    v_mfma_f32_16x16x32_bf16 v[88:91], a[24:27], a[136:139], v[88:91]
    v_mfma_f32_16x16x32_bf16 v[120:123], a[24:27], a[140:143], v[120:123]
    v_mfma_f32_16x16x32_bf16 v[152:155], a[24:27], a[144:147], v[152:155]
    buffer_load_dwordx4 a[212:215], v10, s[28:31], s43 offen
    v_mfma_f32_16x16x32_bf16 v[92:95], a[28:31], a[136:139], v[92:95]
    v_mfma_f32_16x16x32_bf16 v[124:127], a[28:31], a[140:143], v[124:127]
    buffer_load_dwordx4 a[216:219], v11, s[28:31], s43 offen
    v_mfma_f32_16x16x32_bf16 v[156:159], a[28:31], a[144:147], v[156:159]
    s_waitcnt lgkmcnt(0) vmcnt(15)
    s_barrier
    v_mfma_f32_16x16x32_bf16 v[64:67], a[32:35], a[148:151], v[64:67]
    ds_read_b64_tr_b16 a[0:1], v60 offset:0
    v_mfma_f32_16x16x32_bf16 v[96:99], a[32:35], a[152:155], v[96:99]
    ds_read_b64_tr_b16 a[2:3], v60 offset:1024
    v_mfma_f32_16x16x32_bf16 v[128:131], a[32:35], a[156:159], v[128:131]
    ds_read_b64_tr_b16 a[4:5], v60 offset:8
    v_mfma_f32_16x16x32_bf16 v[68:71], a[36:39], a[148:151], v[68:71]
    ds_read_b64_tr_b16 a[6:7], v60 offset:1032
    v_mfma_f32_16x16x32_bf16 v[100:103], a[36:39], a[152:155], v[100:103]
    ds_read_b64_tr_b16 a[8:9], v61 offset:0
    v_mfma_f32_16x16x32_bf16 v[132:135], a[36:39], a[156:159], v[132:135]
    ds_read_b64_tr_b16 a[10:11], v61 offset:1024
    v_mfma_f32_16x16x32_bf16 v[72:75], a[40:43], a[148:151], v[72:75]
    ds_read_b64_tr_b16 a[12:13], v61 offset:8
    v_mfma_f32_16x16x32_bf16 v[104:107], a[40:43], a[152:155], v[104:107]
    ds_read_b64_tr_b16 a[14:15], v61 offset:1032
    v_mfma_f32_16x16x32_bf16 v[136:139], a[40:43], a[156:159], v[136:139]
    ds_read_b64_tr_b16 a[16:17], v62 offset:0
    v_mfma_f32_16x16x32_bf16 v[76:79], a[44:47], a[148:151], v[76:79]
    ds_read_b64_tr_b16 a[18:19], v62 offset:1024
    v_mfma_f32_16x16x32_bf16 v[108:111], a[44:47], a[152:155], v[108:111]
    ds_read_b64_tr_b16 a[20:21], v62 offset:8
    v_mfma_f32_16x16x32_bf16 v[140:143], a[44:47], a[156:159], v[140:143]
    ds_read_b64_tr_b16 a[22:23], v62 offset:1032
    v_mfma_f32_16x16x32_bf16 v[80:83], a[48:51], a[148:151], v[80:83]
    ds_read_b64_tr_b16 a[24:25], v63 offset:0
    v_mfma_f32_16x16x32_bf16 v[112:115], a[48:51], a[152:155], v[112:115]
    ds_read_b64_tr_b16 a[26:27], v63 offset:1024
    v_mfma_f32_16x16x32_bf16 v[144:147], a[48:51], a[156:159], v[144:147]
    ds_read_b64_tr_b16 a[28:29], v63 offset:8
    s_add_u32 s41, s40, 13
    v_mfma_f32_16x16x32_bf16 v[84:87], a[52:55], a[148:151], v[84:87]
    ds_read_b64_tr_b16 a[30:31], v63 offset:1032
    s_and_b32 s41, s41, 15
    s_lshl_b32 s43, s41, 10
    v_mfma_f32_16x16x32_bf16 v[116:119], a[52:55], a[152:155], v[116:119]
    v_mfma_f32_16x16x32_bf16 v[148:151], a[52:55], a[156:159], v[148:151]
    buffer_load_dwordx4 a[220:223], v4, s[28:31], s43 offen
    v_mfma_f32_16x16x32_bf16 v[88:91], a[56:59], a[148:151], v[88:91]
    v_mfma_f32_16x16x32_bf16 v[120:123], a[56:59], a[152:155], v[120:123]
    v_mfma_f32_16x16x32_bf16 v[152:155], a[56:59], a[156:159], v[152:155]
    buffer_load_dwordx4 a[224:227], v10, s[28:31], s43 offen
    v_mfma_f32_16x16x32_bf16 v[92:95], a[60:63], a[148:151], v[92:95]
    v_mfma_f32_16x16x32_bf16 v[124:127], a[60:63], a[152:155], v[124:127]
    buffer_load_dwordx4 a[228:231], v11, s[28:31], s43 offen
    v_mfma_f32_16x16x32_bf16 v[156:159], a[60:63], a[156:159], v[156:159]
    s_waitcnt lgkmcnt(0) vmcnt(15)
    v_mfma_f32_16x16x32_bf16 v[64:67], a[0:3], a[160:163], v[64:67]
    ds_read_b64_tr_b16 a[32:33], v60 offset:8192
    v_mfma_f32_16x16x32_bf16 v[96:99], a[0:3], a[164:167], v[96:99]
    ds_read_b64_tr_b16 a[34:35], v60 offset:9216
    v_mfma_f32_16x16x32_bf16 v[128:131], a[0:3], a[168:171], v[128:131]
    ds_read_b64_tr_b16 a[36:37], v60 offset:8200
    v_mfma_f32_16x16x32_bf16 v[68:71], a[4:7], a[160:163], v[68:71]
    ds_read_b64_tr_b16 a[38:39], v60 offset:9224
    v_mfma_f32_16x16x32_bf16 v[100:103], a[4:7], a[164:167], v[100:103]
    ds_read_b64_tr_b16 a[40:41], v61 offset:8192
    v_mfma_f32_16x16x32_bf16 v[132:135], a[4:7], a[168:171], v[132:135]
    ds_read_b64_tr_b16 a[42:43], v61 offset:9216
    v_mfma_f32_16x16x32_bf16 v[72:75], a[8:11], a[160:163], v[72:75]
    ds_read_b64_tr_b16 a[44:45], v61 offset:8200
    v_mfma_f32_16x16x32_bf16 v[104:107], a[8:11], a[164:167], v[104:107]
    ds_read_b64_tr_b16 a[46:47], v61 offset:9224
    v_mfma_f32_16x16x32_bf16 v[136:139], a[8:11], a[168:171], v[136:139]
    ds_read_b64_tr_b16 a[48:49], v62 offset:8192
    v_mfma_f32_16x16x32_bf16 v[76:79], a[12:15], a[160:163], v[76:79]
    ds_read_b64_tr_b16 a[50:51], v62 offset:9216
    v_mfma_f32_16x16x32_bf16 v[108:111], a[12:15], a[164:167], v[108:111]
    ds_read_b64_tr_b16 a[52:53], v62 offset:8200
    v_mfma_f32_16x16x32_bf16 v[140:143], a[12:15], a[168:171], v[140:143]
    ds_read_b64_tr_b16 a[54:55], v62 offset:9224
    v_mfma_f32_16x16x32_bf16 v[80:83], a[16:19], a[160:163], v[80:83]
    ds_read_b64_tr_b16 a[56:57], v63 offset:8192
    v_mfma_f32_16x16x32_bf16 v[112:115], a[16:19], a[164:167], v[112:115]
    ds_read_b64_tr_b16 a[58:59], v63 offset:9216
    v_mfma_f32_16x16x32_bf16 v[144:147], a[16:19], a[168:171], v[144:147]
    ds_read_b64_tr_b16 a[60:61], v63 offset:8200
    s_add_u32 s41, s40, 14
    v_mfma_f32_16x16x32_bf16 v[84:87], a[20:23], a[160:163], v[84:87]
    ds_read_b64_tr_b16 a[62:63], v63 offset:9224
    s_and_b32 s41, s41, 15
    s_lshl_b32 s43, s41, 10
    v_mfma_f32_16x16x32_bf16 v[116:119], a[20:23], a[164:167], v[116:119]
    v_mfma_f32_16x16x32_bf16 v[148:151], a[20:23], a[168:171], v[148:151]
    buffer_load_dwordx4 a[232:235], v4, s[28:31], s43 offen
    v_mfma_f32_16x16x32_bf16 v[88:91], a[24:27], a[160:163], v[88:91]
    v_mfma_f32_16x16x32_bf16 v[120:123], a[24:27], a[164:167], v[120:123]
    v_mfma_f32_16x16x32_bf16 v[152:155], a[24:27], a[168:171], v[152:155]
    buffer_load_dwordx4 a[236:239], v10, s[28:31], s43 offen
    v_mfma_f32_16x16x32_bf16 v[92:95], a[28:31], a[160:163], v[92:95]
    v_mfma_f32_16x16x32_bf16 v[124:127], a[28:31], a[164:167], v[124:127]
    buffer_load_dwordx4 a[240:243], v11, s[28:31], s43 offen
    v_mfma_f32_16x16x32_bf16 v[156:159], a[28:31], a[168:171], v[156:159]
    s_waitcnt lgkmcnt(0) vmcnt(15)
    s_barrier
    v_mfma_f32_16x16x32_bf16 v[64:67], a[32:35], a[172:175], v[64:67]
    ds_read_b64_tr_b16 a[0:1], v60 offset:16384
    v_mfma_f32_16x16x32_bf16 v[96:99], a[32:35], a[176:179], v[96:99]
    ds_read_b64_tr_b16 a[2:3], v60 offset:17408
    v_mfma_f32_16x16x32_bf16 v[128:131], a[32:35], a[180:183], v[128:131]
    ds_read_b64_tr_b16 a[4:5], v60 offset:16392
    v_mfma_f32_16x16x32_bf16 v[68:71], a[36:39], a[172:175], v[68:71]
    ds_read_b64_tr_b16 a[6:7], v60 offset:17416
    v_mfma_f32_16x16x32_bf16 v[100:103], a[36:39], a[176:179], v[100:103]
    ds_read_b64_tr_b16 a[8:9], v61 offset:16384
    v_mfma_f32_16x16x32_bf16 v[132:135], a[36:39], a[180:183], v[132:135]
    ds_read_b64_tr_b16 a[10:11], v61 offset:17408
    v_mfma_f32_16x16x32_bf16 v[72:75], a[40:43], a[172:175], v[72:75]
    ds_read_b64_tr_b16 a[12:13], v61 offset:16392
    v_mfma_f32_16x16x32_bf16 v[104:107], a[40:43], a[176:179], v[104:107]
    ds_read_b64_tr_b16 a[14:15], v61 offset:17416
    v_mfma_f32_16x16x32_bf16 v[136:139], a[40:43], a[180:183], v[136:139]
    ds_read_b64_tr_b16 a[16:17], v62 offset:16384
    v_mfma_f32_16x16x32_bf16 v[76:79], a[44:47], a[172:175], v[76:79]
    ds_read_b64_tr_b16 a[18:19], v62 offset:17408
    v_mfma_f32_16x16x32_bf16 v[108:111], a[44:47], a[176:179], v[108:111]
    ds_read_b64_tr_b16 a[20:21], v62 offset:16392
    v_mfma_f32_16x16x32_bf16 v[140:143], a[44:47], a[180:183], v[140:143]
    ds_read_b64_tr_b16 a[22:23], v62 offset:17416
    v_mfma_f32_16x16x32_bf16 v[80:83], a[48:51], a[172:175], v[80:83]
    ds_read_b64_tr_b16 a[24:25], v63 offset:16384
    v_mfma_f32_16x16x32_bf16 v[112:115], a[48:51], a[176:179], v[112:115]
    ds_read_b64_tr_b16 a[26:27], v63 offset:17408
    v_mfma_f32_16x16x32_bf16 v[144:147], a[48:51], a[180:183], v[144:147]
    ds_read_b64_tr_b16 a[28:29], v63 offset:16392
    s_add_u32 s41, s40, 15
    v_mfma_f32_16x16x32_bf16 v[84:87], a[52:55], a[172:175], v[84:87]
    ds_read_b64_tr_b16 a[30:31], v63 offset:17416
    s_and_b32 s41, s41, 15
    s_lshl_b32 s43, s41, 10
    v_mfma_f32_16x16x32_bf16 v[116:119], a[52:55], a[176:179], v[116:119]
    v_mfma_f32_16x16x32_bf16 v[148:151], a[52:55], a[180:183], v[148:151]
    buffer_load_dwordx4 a[244:247], v4, s[28:31], s43 offen
    v_mfma_f32_16x16x32_bf16 v[88:91], a[56:59], a[172:175], v[88:91]
    v_mfma_f32_16x16x32_bf16 v[120:123], a[56:59], a[176:179], v[120:123]
    v_mfma_f32_16x16x32_bf16 v[152:155], a[56:59], a[180:183], v[152:155]
    buffer_load_dwordx4 a[248:251], v10, s[28:31], s43 offen
    v_mfma_f32_16x16x32_bf16 v[92:95], a[60:63], a[172:175], v[92:95]
    v_mfma_f32_16x16x32_bf16 v[124:127], a[60:63], a[176:179], v[124:127]
    buffer_load_dwordx4 a[252:255], v11, s[28:31], s43 offen
    v_mfma_f32_16x16x32_bf16 v[156:159], a[60:63], a[180:183], v[156:159]
    s_waitcnt lgkmcnt(0) vmcnt(15)
    v_mfma_f32_16x16x32_bf16 v[64:67], a[0:3], a[184:187], v[64:67]
    ds_read_b64_tr_b16 a[32:33], v60 offset:24576
    v_mfma_f32_16x16x32_bf16 v[96:99], a[0:3], a[188:191], v[96:99]
    ds_read_b64_tr_b16 a[34:35], v60 offset:25600
    v_mfma_f32_16x16x32_bf16 v[128:131], a[0:3], a[192:195], v[128:131]
    ds_read_b64_tr_b16 a[36:37], v60 offset:24584
    v_mfma_f32_16x16x32_bf16 v[68:71], a[4:7], a[184:187], v[68:71]
    ds_read_b64_tr_b16 a[38:39], v60 offset:25608
    v_mfma_f32_16x16x32_bf16 v[100:103], a[4:7], a[188:191], v[100:103]
    ds_read_b64_tr_b16 a[40:41], v61 offset:24576
    v_mfma_f32_16x16x32_bf16 v[132:135], a[4:7], a[192:195], v[132:135]
    ds_read_b64_tr_b16 a[42:43], v61 offset:25600
    v_mfma_f32_16x16x32_bf16 v[72:75], a[8:11], a[184:187], v[72:75]
    ds_read_b64_tr_b16 a[44:45], v61 offset:24584
    v_mfma_f32_16x16x32_bf16 v[104:107], a[8:11], a[188:191], v[104:107]
    ds_read_b64_tr_b16 a[46:47], v61 offset:25608
    v_mfma_f32_16x16x32_bf16 v[136:139], a[8:11], a[192:195], v[136:139]
    ds_read_b64_tr_b16 a[48:49], v62 offset:24576
    v_mfma_f32_16x16x32_bf16 v[76:79], a[12:15], a[184:187], v[76:79]
    ds_read_b64_tr_b16 a[50:51], v62 offset:25600
    v_mfma_f32_16x16x32_bf16 v[108:111], a[12:15], a[188:191], v[108:111]
    ds_read_b64_tr_b16 a[52:53], v62 offset:24584
    v_mfma_f32_16x16x32_bf16 v[140:143], a[12:15], a[192:195], v[140:143]
    ds_read_b64_tr_b16 a[54:55], v62 offset:25608
    v_mfma_f32_16x16x32_bf16 v[80:83], a[16:19], a[184:187], v[80:83]
    ds_read_b64_tr_b16 a[56:57], v63 offset:24576
    v_mfma_f32_16x16x32_bf16 v[112:115], a[16:19], a[188:191], v[112:115]
    ds_read_b64_tr_b16 a[58:59], v63 offset:25600
    v_mfma_f32_16x16x32_bf16 v[144:147], a[16:19], a[192:195], v[144:147]
    ds_read_b64_tr_b16 a[60:61], v63 offset:24584
    v_mfma_f32_16x16x32_bf16 v[84:87], a[20:23], a[184:187], v[84:87]
    ds_read_b64_tr_b16 a[62:63], v63 offset:25608
    v_mfma_f32_16x16x32_bf16 v[116:119], a[20:23], a[188:191], v[116:119]
    v_mfma_f32_16x16x32_bf16 v[148:151], a[20:23], a[192:195], v[148:151]
    v_mfma_f32_16x16x32_bf16 v[88:91], a[24:27], a[184:187], v[88:91]
    v_mfma_f32_16x16x32_bf16 v[120:123], a[24:27], a[188:191], v[120:123]
    v_mfma_f32_16x16x32_bf16 v[152:155], a[24:27], a[192:195], v[152:155]
    v_mfma_f32_16x16x32_bf16 v[92:95], a[28:31], a[184:187], v[92:95]
    v_mfma_f32_16x16x32_bf16 v[124:127], a[28:31], a[188:191], v[124:127]
    v_mfma_f32_16x16x32_bf16 v[156:159], a[28:31], a[192:195], v[156:159]
    s_waitcnt lgkmcnt(0) vmcnt(12)
    s_barrier
    v_mfma_f32_16x16x32_bf16 v[64:67], a[32:35], a[196:199], v[64:67]
    ds_read_b64_tr_b16 a[0:1], v60 offset:32768
    v_mfma_f32_16x16x32_bf16 v[96:99], a[32:35], a[200:203], v[96:99]
    ds_read_b64_tr_b16 a[2:3], v60 offset:33792
    v_mfma_f32_16x16x32_bf16 v[128:131], a[32:35], a[204:207], v[128:131]
    ds_read_b64_tr_b16 a[4:5], v60 offset:32776
    v_mfma_f32_16x16x32_bf16 v[68:71], a[36:39], a[196:199], v[68:71]
    ds_read_b64_tr_b16 a[6:7], v60 offset:33800
    v_mfma_f32_16x16x32_bf16 v[100:103], a[36:39], a[200:203], v[100:103]
    ds_read_b64_tr_b16 a[8:9], v61 offset:32768
    v_mfma_f32_16x16x32_bf16 v[132:135], a[36:39], a[204:207], v[132:135]
    ds_read_b64_tr_b16 a[10:11], v61 offset:33792
    v_mfma_f32_16x16x32_bf16 v[72:75], a[40:43], a[196:199], v[72:75]
    ds_read_b64_tr_b16 a[12:13], v61 offset:32776
    v_mfma_f32_16x16x32_bf16 v[104:107], a[40:43], a[200:203], v[104:107]
    ds_read_b64_tr_b16 a[14:15], v61 offset:33800
    v_mfma_f32_16x16x32_bf16 v[136:139], a[40:43], a[204:207], v[136:139]
    ds_read_b64_tr_b16 a[16:17], v62 offset:32768
    v_mfma_f32_16x16x32_bf16 v[76:79], a[44:47], a[196:199], v[76:79]
    ds_read_b64_tr_b16 a[18:19], v62 offset:33792
    v_mfma_f32_16x16x32_bf16 v[108:111], a[44:47], a[200:203], v[108:111]
    ds_read_b64_tr_b16 a[20:21], v62 offset:32776
    v_mfma_f32_16x16x32_bf16 v[140:143], a[44:47], a[204:207], v[140:143]
    ds_read_b64_tr_b16 a[22:23], v62 offset:33800
    v_mfma_f32_16x16x32_bf16 v[80:83], a[48:51], a[196:199], v[80:83]
    ds_read_b64_tr_b16 a[24:25], v63 offset:32768
    v_mfma_f32_16x16x32_bf16 v[112:115], a[48:51], a[200:203], v[112:115]
    ds_read_b64_tr_b16 a[26:27], v63 offset:33792
    v_mfma_f32_16x16x32_bf16 v[144:147], a[48:51], a[204:207], v[144:147]
    ds_read_b64_tr_b16 a[28:29], v63 offset:32776
    v_mfma_f32_16x16x32_bf16 v[84:87], a[52:55], a[196:199], v[84:87]
    ds_read_b64_tr_b16 a[30:31], v63 offset:33800
    v_mfma_f32_16x16x32_bf16 v[116:119], a[52:55], a[200:203], v[116:119]
    v_mfma_f32_16x16x32_bf16 v[148:151], a[52:55], a[204:207], v[148:151]
    v_mfma_f32_16x16x32_bf16 v[88:91], a[56:59], a[196:199], v[88:91]
    v_mfma_f32_16x16x32_bf16 v[120:123], a[56:59], a[200:203], v[120:123]
    v_mfma_f32_16x16x32_bf16 v[152:155], a[56:59], a[204:207], v[152:155]
    v_mfma_f32_16x16x32_bf16 v[92:95], a[60:63], a[196:199], v[92:95]
    v_mfma_f32_16x16x32_bf16 v[124:127], a[60:63], a[200:203], v[124:127]
    v_mfma_f32_16x16x32_bf16 v[156:159], a[60:63], a[204:207], v[156:159]
    s_waitcnt lgkmcnt(0) vmcnt(9)
    v_mfma_f32_16x16x32_bf16 v[64:67], a[0:3], a[208:211], v[64:67]
    ds_read_b64_tr_b16 a[32:33], v60 offset:40960
    v_mfma_f32_16x16x32_bf16 v[96:99], a[0:3], a[212:215], v[96:99]
    ds_read_b64_tr_b16 a[34:35], v60 offset:41984
    v_mfma_f32_16x16x32_bf16 v[128:131], a[0:3], a[216:219], v[128:131]
    ds_read_b64_tr_b16 a[36:37], v60 offset:40968
    v_mfma_f32_16x16x32_bf16 v[68:71], a[4:7], a[208:211], v[68:71]
    ds_read_b64_tr_b16 a[38:39], v60 offset:41992
    v_mfma_f32_16x16x32_bf16 v[100:103], a[4:7], a[212:215], v[100:103]
    ds_read_b64_tr_b16 a[40:41], v61 offset:40960
    v_mfma_f32_16x16x32_bf16 v[132:135], a[4:7], a[216:219], v[132:135]
    ds_read_b64_tr_b16 a[42:43], v61 offset:41984
    v_mfma_f32_16x16x32_bf16 v[72:75], a[8:11], a[208:211], v[72:75]
    ds_read_b64_tr_b16 a[44:45], v61 offset:40968
    v_mfma_f32_16x16x32_bf16 v[104:107], a[8:11], a[212:215], v[104:107]
    ds_read_b64_tr_b16 a[46:47], v61 offset:41992
    v_mfma_f32_16x16x32_bf16 v[136:139], a[8:11], a[216:219], v[136:139]
    ds_read_b64_tr_b16 a[48:49], v62 offset:40960
    v_mfma_f32_16x16x32_bf16 v[76:79], a[12:15], a[208:211], v[76:79]
    ds_read_b64_tr_b16 a[50:51], v62 offset:41984
    v_mfma_f32_16x16x32_bf16 v[108:111], a[12:15], a[212:215], v[108:111]
    ds_read_b64_tr_b16 a[52:53], v62 offset:40968
    v_mfma_f32_16x16x32_bf16 v[140:143], a[12:15], a[216:219], v[140:143]
    ds_read_b64_tr_b16 a[54:55], v62 offset:41992
    v_mfma_f32_16x16x32_bf16 v[80:83], a[16:19], a[208:211], v[80:83]
    ds_read_b64_tr_b16 a[56:57], v63 offset:40960
    v_mfma_f32_16x16x32_bf16 v[112:115], a[16:19], a[212:215], v[112:115]
    ds_read_b64_tr_b16 a[58:59], v63 offset:41984
    v_mfma_f32_16x16x32_bf16 v[144:147], a[16:19], a[216:219], v[144:147]
    ds_read_b64_tr_b16 a[60:61], v63 offset:40968
    v_mfma_f32_16x16x32_bf16 v[84:87], a[20:23], a[208:211], v[84:87]
    ds_read_b64_tr_b16 a[62:63], v63 offset:41992
    v_mfma_f32_16x16x32_bf16 v[116:119], a[20:23], a[212:215], v[116:119]
    v_mfma_f32_16x16x32_bf16 v[148:151], a[20:23], a[216:219], v[148:151]
    v_mfma_f32_16x16x32_bf16 v[88:91], a[24:27], a[208:211], v[88:91]
    v_mfma_f32_16x16x32_bf16 v[120:123], a[24:27], a[212:215], v[120:123]
    v_mfma_f32_16x16x32_bf16 v[152:155], a[24:27], a[216:219], v[152:155]
    v_mfma_f32_16x16x32_bf16 v[92:95], a[28:31], a[208:211], v[92:95]
    v_mfma_f32_16x16x32_bf16 v[124:127], a[28:31], a[212:215], v[124:127]
    v_mfma_f32_16x16x32_bf16 v[156:159], a[28:31], a[216:219], v[156:159]
    s_waitcnt lgkmcnt(0) vmcnt(6)
    s_barrier
    v_mfma_f32_16x16x32_bf16 v[64:67], a[32:35], a[220:223], v[64:67]
    ds_read_b64_tr_b16 a[0:1], v60 offset:49152
    v_mfma_f32_16x16x32_bf16 v[96:99], a[32:35], a[224:227], v[96:99]
    ds_read_b64_tr_b16 a[2:3], v60 offset:50176
    v_mfma_f32_16x16x32_bf16 v[128:131], a[32:35], a[228:231], v[128:131]
    ds_read_b64_tr_b16 a[4:5], v60 offset:49160
    v_mfma_f32_16x16x32_bf16 v[68:71], a[36:39], a[220:223], v[68:71]
    ds_read_b64_tr_b16 a[6:7], v60 offset:50184
    v_mfma_f32_16x16x32_bf16 v[100:103], a[36:39], a[224:227], v[100:103]
    ds_read_b64_tr_b16 a[8:9], v61 offset:49152
    v_mfma_f32_16x16x32_bf16 v[132:135], a[36:39], a[228:231], v[132:135]
    ds_read_b64_tr_b16 a[10:11], v61 offset:50176
    v_mfma_f32_16x16x32_bf16 v[72:75], a[40:43], a[220:223], v[72:75]
    ds_read_b64_tr_b16 a[12:13], v61 offset:49160
    v_mfma_f32_16x16x32_bf16 v[104:107], a[40:43], a[224:227], v[104:107]
    ds_read_b64_tr_b16 a[14:15], v61 offset:50184
    v_mfma_f32_16x16x32_bf16 v[136:139], a[40:43], a[228:231], v[136:139]
    ds_read_b64_tr_b16 a[16:17], v62 offset:49152
    v_mfma_f32_16x16x32_bf16 v[76:79], a[44:47], a[220:223], v[76:79]
    ds_read_b64_tr_b16 a[18:19], v62 offset:50176
    v_mfma_f32_16x16x32_bf16 v[108:111], a[44:47], a[224:227], v[108:111]
    ds_read_b64_tr_b16 a[20:21], v62 offset:49160
    v_mfma_f32_16x16x32_bf16 v[140:143], a[44:47], a[228:231], v[140:143]
    ds_read_b64_tr_b16 a[22:23], v62 offset:50184
    v_mfma_f32_16x16x32_bf16 v[80:83], a[48:51], a[220:223], v[80:83]
    ds_read_b64_tr_b16 a[24:25], v63 offset:49152
    v_mfma_f32_16x16x32_bf16 v[112:115], a[48:51], a[224:227], v[112:115]
    ds_read_b64_tr_b16 a[26:27], v63 offset:50176
    v_mfma_f32_16x16x32_bf16 v[144:147], a[48:51], a[228:231], v[144:147]
    ds_read_b64_tr_b16 a[28:29], v63 offset:49160
    v_mfma_f32_16x16x32_bf16 v[84:87], a[52:55], a[220:223], v[84:87]
    ds_read_b64_tr_b16 a[30:31], v63 offset:50184
    v_mfma_f32_16x16x32_bf16 v[116:119], a[52:55], a[224:227], v[116:119]
    v_mfma_f32_16x16x32_bf16 v[148:151], a[52:55], a[228:231], v[148:151]
    v_mfma_f32_16x16x32_bf16 v[88:91], a[56:59], a[220:223], v[88:91]
    v_mfma_f32_16x16x32_bf16 v[120:123], a[56:59], a[224:227], v[120:123]
    v_mfma_f32_16x16x32_bf16 v[152:155], a[56:59], a[228:231], v[152:155]
    v_mfma_f32_16x16x32_bf16 v[92:95], a[60:63], a[220:223], v[92:95]
    v_mfma_f32_16x16x32_bf16 v[124:127], a[60:63], a[224:227], v[124:127]
    v_mfma_f32_16x16x32_bf16 v[156:159], a[60:63], a[228:231], v[156:159]
    s_waitcnt lgkmcnt(0) vmcnt(3)
    v_mfma_f32_16x16x32_bf16 v[64:67], a[0:3], a[232:235], v[64:67]
    ds_read_b64_tr_b16 a[32:33], v60 offset:57344
    v_mfma_f32_16x16x32_bf16 v[96:99], a[0:3], a[236:239], v[96:99]
    ds_read_b64_tr_b16 a[34:35], v60 offset:58368
    v_mfma_f32_16x16x32_bf16 v[128:131], a[0:3], a[240:243], v[128:131]
    ds_read_b64_tr_b16 a[36:37], v60 offset:57352
    v_mfma_f32_16x16x32_bf16 v[68:71], a[4:7], a[232:235], v[68:71]
    ds_read_b64_tr_b16 a[38:39], v60 offset:58376
    v_mfma_f32_16x16x32_bf16 v[100:103], a[4:7], a[236:239], v[100:103]
    ds_read_b64_tr_b16 a[40:41], v61 offset:57344
    v_mfma_f32_16x16x32_bf16 v[132:135], a[4:7], a[240:243], v[132:135]
    ds_read_b64_tr_b16 a[42:43], v61 offset:58368
    v_mfma_f32_16x16x32_bf16 v[72:75], a[8:11], a[232:235], v[72:75]
    ds_read_b64_tr_b16 a[44:45], v61 offset:57352
    v_mfma_f32_16x16x32_bf16 v[104:107], a[8:11], a[236:239], v[104:107]
    ds_read_b64_tr_b16 a[46:47], v61 offset:58376
    v_mfma_f32_16x16x32_bf16 v[136:139], a[8:11], a[240:243], v[136:139]
    ds_read_b64_tr_b16 a[48:49], v62 offset:57344
    v_mfma_f32_16x16x32_bf16 v[76:79], a[12:15], a[232:235], v[76:79]
    ds_read_b64_tr_b16 a[50:51], v62 offset:58368
    v_mfma_f32_16x16x32_bf16 v[108:111], a[12:15], a[236:239], v[108:111]
    ds_read_b64_tr_b16 a[52:53], v62 offset:57352
    v_mfma_f32_16x16x32_bf16 v[140:143], a[12:15], a[240:243], v[140:143]
    ds_read_b64_tr_b16 a[54:55], v62 offset:58376
    v_mfma_f32_16x16x32_bf16 v[80:83], a[16:19], a[232:235], v[80:83]
    ds_read_b64_tr_b16 a[56:57], v63 offset:57344
    v_mfma_f32_16x16x32_bf16 v[112:115], a[16:19], a[236:239], v[112:115]
    ds_read_b64_tr_b16 a[58:59], v63 offset:58368
    v_mfma_f32_16x16x32_bf16 v[144:147], a[16:19], a[240:243], v[144:147]
    ds_read_b64_tr_b16 a[60:61], v63 offset:57352
    v_mfma_f32_16x16x32_bf16 v[84:87], a[20:23], a[232:235], v[84:87]
    ds_read_b64_tr_b16 a[62:63], v63 offset:58376
    v_mfma_f32_16x16x32_bf16 v[116:119], a[20:23], a[236:239], v[116:119]
    v_mfma_f32_16x16x32_bf16 v[148:151], a[20:23], a[240:243], v[148:151]
    v_mfma_f32_16x16x32_bf16 v[88:91], a[24:27], a[232:235], v[88:91]
    v_mfma_f32_16x16x32_bf16 v[120:123], a[24:27], a[236:239], v[120:123]
    v_mfma_f32_16x16x32_bf16 v[152:155], a[24:27], a[240:243], v[152:155]
    v_mfma_f32_16x16x32_bf16 v[92:95], a[28:31], a[232:235], v[92:95]
    v_mfma_f32_16x16x32_bf16 v[124:127], a[28:31], a[236:239], v[124:127]
    v_mfma_f32_16x16x32_bf16 v[156:159], a[28:31], a[240:243], v[156:159]
    s_waitcnt lgkmcnt(0) vmcnt(0)
    v_mfma_f32_16x16x32_bf16 v[64:67], a[32:35], a[244:247], v[64:67]
    v_mfma_f32_16x16x32_bf16 v[96:99], a[32:35], a[248:251], v[96:99]
    v_mfma_f32_16x16x32_bf16 v[128:131], a[32:35], a[252:255], v[128:131]
    v_mfma_f32_16x16x32_bf16 v[68:71], a[36:39], a[244:247], v[68:71]
    v_mfma_f32_16x16x32_bf16 v[100:103], a[36:39], a[248:251], v[100:103]
    v_mfma_f32_16x16x32_bf16 v[132:135], a[36:39], a[252:255], v[132:135]
    v_mfma_f32_16x16x32_bf16 v[72:75], a[40:43], a[244:247], v[72:75]
    v_mfma_f32_16x16x32_bf16 v[104:107], a[40:43], a[248:251], v[104:107]
    v_mfma_f32_16x16x32_bf16 v[136:139], a[40:43], a[252:255], v[136:139]
    v_mfma_f32_16x16x32_bf16 v[76:79], a[44:47], a[244:247], v[76:79]
    v_mfma_f32_16x16x32_bf16 v[108:111], a[44:47], a[248:251], v[108:111]
    v_mfma_f32_16x16x32_bf16 v[140:143], a[44:47], a[252:255], v[140:143]
    v_mfma_f32_16x16x32_bf16 v[80:83], a[48:51], a[244:247], v[80:83]
    v_mfma_f32_16x16x32_bf16 v[112:115], a[48:51], a[248:251], v[112:115]
    v_mfma_f32_16x16x32_bf16 v[144:147], a[48:51], a[252:255], v[144:147]
    v_mfma_f32_16x16x32_bf16 v[84:87], a[52:55], a[244:247], v[84:87]
    v_mfma_f32_16x16x32_bf16 v[116:119], a[52:55], a[248:251], v[116:119]
    v_mfma_f32_16x16x32_bf16 v[148:151], a[52:55], a[252:255], v[148:151]
    v_mfma_f32_16x16x32_bf16 v[88:91], a[56:59], a[244:247], v[88:91]
    v_mfma_f32_16x16x32_bf16 v[120:123], a[56:59], a[248:251], v[120:123]
    v_mfma_f32_16x16x32_bf16 v[152:155], a[56:59], a[252:255], v[152:155]
    v_mfma_f32_16x16x32_bf16 v[92:95], a[60:63], a[244:247], v[92:95]
    v_mfma_f32_16x16x32_bf16 v[124:127], a[60:63], a[248:251], v[124:127]
    v_mfma_f32_16x16x32_bf16 v[156:159], a[60:63], a[252:255], v[156:159]
    s_nop 15
    s_mul_i32 s19, s16, 98304
    v_lshlrev_b32 v3, 4, v0
    v_add_u32 v3, s19, v3
    s_mov_b32 s19, 0
    s_mov_b32 s20, 4096
    buffer_store_dwordx4 v[64:67], v3, s[32:35], s19 offen offset:0 sc0 sc1
    buffer_store_dwordx4 v[68:71], v3, s[32:35], s19 offen offset:1024 sc0 sc1
    buffer_store_dwordx4 v[72:75], v3, s[32:35], s19 offen offset:2048 sc0 sc1
    buffer_store_dwordx4 v[76:79], v3, s[32:35], s19 offen offset:3072 sc0 sc1
    buffer_store_dwordx4 v[80:83], v3, s[32:35], s20 offen offset:0 sc0 sc1
    buffer_store_dwordx4 v[84:87], v3, s[32:35], s20 offen offset:1024 sc0 sc1
    buffer_store_dwordx4 v[88:91], v3, s[32:35], s20 offen offset:2048 sc0 sc1
    buffer_store_dwordx4 v[92:95], v3, s[32:35], s20 offen offset:3072 sc0 sc1
    s_mov_b32 s19, 32768
    s_mov_b32 s20, 36864
    buffer_store_dwordx4 v[96:99], v3, s[32:35], s19 offen offset:0 sc0 sc1
    buffer_store_dwordx4 v[100:103], v3, s[32:35], s19 offen offset:1024 sc0 sc1
    buffer_store_dwordx4 v[104:107], v3, s[32:35], s19 offen offset:2048 sc0 sc1
    buffer_store_dwordx4 v[108:111], v3, s[32:35], s19 offen offset:3072 sc0 sc1
    buffer_store_dwordx4 v[112:115], v3, s[32:35], s20 offen offset:0 sc0 sc1
    buffer_store_dwordx4 v[116:119], v3, s[32:35], s20 offen offset:1024 sc0 sc1
    buffer_store_dwordx4 v[120:123], v3, s[32:35], s20 offen offset:2048 sc0 sc1
    buffer_store_dwordx4 v[124:127], v3, s[32:35], s20 offen offset:3072 sc0 sc1
    s_mov_b32 s19, 65536
    s_mov_b32 s20, 69632
    buffer_store_dwordx4 v[128:131], v3, s[32:35], s19 offen offset:0 sc0 sc1
    buffer_store_dwordx4 v[132:135], v3, s[32:35], s19 offen offset:1024 sc0 sc1
    buffer_store_dwordx4 v[136:139], v3, s[32:35], s19 offen offset:2048 sc0 sc1
    buffer_store_dwordx4 v[140:143], v3, s[32:35], s19 offen offset:3072 sc0 sc1
    buffer_store_dwordx4 v[144:147], v3, s[32:35], s20 offen offset:0 sc0 sc1
    buffer_store_dwordx4 v[148:151], v3, s[32:35], s20 offen offset:1024 sc0 sc1
    buffer_store_dwordx4 v[152:155], v3, s[32:35], s20 offen offset:2048 sc0 sc1
    buffer_store_dwordx4 v[156:159], v3, s[32:35], s20 offen offset:3072 sc0 sc1
    s_branch O_END
O_LOADER:
    v_xor_b32 v3, v2, v1
    v_lshlrev_b32 v3, 4, v3
    v_lshl_add_u32 v3, v1, 10, v3
    s_add_u32 s41, s40, 0
    s_and_b32 s41, s41, 15
    s_lshl_b32 s42, s41, 15
    s_waitcnt vmcnt(59)
    s_mov_b32 m0, 0
    s_add_u32 s17, s42, 0
    buffer_load_dwordx4 v3, s[24:27], s17 offen offset:0 lds
    s_add_u32 s17, s42, 3072
    buffer_load_dwordx4 v3, s[24:27], s17 offen offset:1024 lds
    s_add_u32 s17, s42, 6144
    buffer_load_dwordx4 v3, s[24:27], s17 offen offset:2048 lds
    s_add_u32 s17, s42, 9216
    buffer_load_dwordx4 v3, s[24:27], s17 offen offset:3072 lds
    s_waitcnt vmcnt(59)
    s_mov_b32 m0, 4096
    s_add_u32 s17, s42, 16384
    buffer_load_dwordx4 v3, s[24:27], s17 offen offset:0 lds
    s_add_u32 s17, s42, 19456
    buffer_load_dwordx4 v3, s[24:27], s17 offen offset:1024 lds
    s_add_u32 s17, s42, 22528
    buffer_load_dwordx4 v3, s[24:27], s17 offen offset:2048 lds
    s_add_u32 s17, s42, 25600
    buffer_load_dwordx4 v3, s[24:27], s17 offen offset:3072 lds
    s_add_u32 s41, s40, 1
    s_and_b32 s41, s41, 15
    s_lshl_b32 s42, s41, 15
    s_waitcnt vmcnt(59)
    s_mov_b32 m0, 8192
    s_add_u32 s17, s42, 0
    buffer_load_dwordx4 v3, s[24:27], s17 offen offset:0 lds
    s_add_u32 s17, s42, 3072
    buffer_load_dwordx4 v3, s[24:27], s17 offen offset:1024 lds
    s_add_u32 s17, s42, 6144
    buffer_load_dwordx4 v3, s[24:27], s17 offen offset:2048 lds
    s_add_u32 s17, s42, 9216
    buffer_load_dwordx4 v3, s[24:27], s17 offen offset:3072 lds
    s_waitcnt vmcnt(59)
    s_mov_b32 m0, 12288
    s_add_u32 s17, s42, 16384
    buffer_load_dwordx4 v3, s[24:27], s17 offen offset:0 lds
    s_add_u32 s17, s42, 19456
    buffer_load_dwordx4 v3, s[24:27], s17 offen offset:1024 lds
    s_add_u32 s17, s42, 22528
    buffer_load_dwordx4 v3, s[24:27], s17 offen offset:2048 lds
    s_add_u32 s17, s42, 25600
    buffer_load_dwordx4 v3, s[24:27], s17 offen offset:3072 lds
    s_add_u32 s41, s40, 2
    s_and_b32 s41, s41, 15
    s_lshl_b32 s42, s41, 15
    s_waitcnt vmcnt(59)
    s_mov_b32 m0, 16384
    s_add_u32 s17, s42, 0
    buffer_load_dwordx4 v3, s[24:27], s17 offen offset:0 lds
    s_add_u32 s17, s42, 3072
    buffer_load_dwordx4 v3, s[24:27], s17 offen offset:1024 lds
    s_add_u32 s17, s42, 6144
    buffer_load_dwordx4 v3, s[24:27], s17 offen offset:2048 lds
    s_add_u32 s17, s42, 9216
    buffer_load_dwordx4 v3, s[24:27], s17 offen offset:3072 lds
    s_waitcnt vmcnt(59)
    s_mov_b32 m0, 20480
    s_add_u32 s17, s42, 16384
    buffer_load_dwordx4 v3, s[24:27], s17 offen offset:0 lds
    s_add_u32 s17, s42, 19456
    buffer_load_dwordx4 v3, s[24:27], s17 offen offset:1024 lds
    s_add_u32 s17, s42, 22528
    buffer_load_dwordx4 v3, s[24:27], s17 offen offset:2048 lds
    s_add_u32 s17, s42, 25600
    buffer_load_dwordx4 v3, s[24:27], s17 offen offset:3072 lds
    s_add_u32 s41, s40, 3
    s_and_b32 s41, s41, 15
    s_lshl_b32 s42, s41, 15
    s_waitcnt vmcnt(59)
    s_mov_b32 m0, 24576
    s_add_u32 s17, s42, 0
    buffer_load_dwordx4 v3, s[24:27], s17 offen offset:0 lds
    s_add_u32 s17, s42, 3072
    buffer_load_dwordx4 v3, s[24:27], s17 offen offset:1024 lds
    s_add_u32 s17, s42, 6144
    buffer_load_dwordx4 v3, s[24:27], s17 offen offset:2048 lds
    s_add_u32 s17, s42, 9216
    buffer_load_dwordx4 v3, s[24:27], s17 offen offset:3072 lds
    s_waitcnt vmcnt(59)
    s_mov_b32 m0, 28672
    s_add_u32 s17, s42, 16384
    buffer_load_dwordx4 v3, s[24:27], s17 offen offset:0 lds
    s_add_u32 s17, s42, 19456
    buffer_load_dwordx4 v3, s[24:27], s17 offen offset:1024 lds
    s_add_u32 s17, s42, 22528
    buffer_load_dwordx4 v3, s[24:27], s17 offen offset:2048 lds
    s_add_u32 s17, s42, 25600
    buffer_load_dwordx4 v3, s[24:27], s17 offen offset:3072 lds
    s_add_u32 s41, s40, 4
    s_and_b32 s41, s41, 15
    s_lshl_b32 s42, s41, 15
    s_waitcnt vmcnt(59)
    s_mov_b32 m0, 32768
    s_add_u32 s17, s42, 0
    buffer_load_dwordx4 v3, s[24:27], s17 offen offset:0 lds
    s_add_u32 s17, s42, 3072
    buffer_load_dwordx4 v3, s[24:27], s17 offen offset:1024 lds
    s_add_u32 s17, s42, 6144
    buffer_load_dwordx4 v3, s[24:27], s17 offen offset:2048 lds
    s_add_u32 s17, s42, 9216
    buffer_load_dwordx4 v3, s[24:27], s17 offen offset:3072 lds
    s_waitcnt vmcnt(59)
    s_mov_b32 m0, 36864
    s_add_u32 s17, s42, 16384
    buffer_load_dwordx4 v3, s[24:27], s17 offen offset:0 lds
    s_add_u32 s17, s42, 19456
    buffer_load_dwordx4 v3, s[24:27], s17 offen offset:1024 lds
    s_add_u32 s17, s42, 22528
    buffer_load_dwordx4 v3, s[24:27], s17 offen offset:2048 lds
    s_add_u32 s17, s42, 25600
    buffer_load_dwordx4 v3, s[24:27], s17 offen offset:3072 lds
    s_add_u32 s41, s40, 5
    s_and_b32 s41, s41, 15
    s_lshl_b32 s42, s41, 15
    s_waitcnt vmcnt(59)
    s_mov_b32 m0, 40960
    s_add_u32 s17, s42, 0
    buffer_load_dwordx4 v3, s[24:27], s17 offen offset:0 lds
    s_add_u32 s17, s42, 3072
    buffer_load_dwordx4 v3, s[24:27], s17 offen offset:1024 lds
    s_add_u32 s17, s42, 6144
    buffer_load_dwordx4 v3, s[24:27], s17 offen offset:2048 lds
    s_add_u32 s17, s42, 9216
    buffer_load_dwordx4 v3, s[24:27], s17 offen offset:3072 lds
    s_waitcnt vmcnt(59)
    s_mov_b32 m0, 45056
    s_add_u32 s17, s42, 16384
    buffer_load_dwordx4 v3, s[24:27], s17 offen offset:0 lds
    s_add_u32 s17, s42, 19456
    buffer_load_dwordx4 v3, s[24:27], s17 offen offset:1024 lds
    s_add_u32 s17, s42, 22528
    buffer_load_dwordx4 v3, s[24:27], s17 offen offset:2048 lds
    s_add_u32 s17, s42, 25600
    buffer_load_dwordx4 v3, s[24:27], s17 offen offset:3072 lds
    s_waitcnt vmcnt(32)
    s_barrier
    s_add_u32 s41, s40, 6
    s_and_b32 s41, s41, 15
    s_lshl_b32 s42, s41, 15
    s_waitcnt vmcnt(59)
    s_mov_b32 m0, 49152
    s_add_u32 s17, s42, 0
    buffer_load_dwordx4 v3, s[24:27], s17 offen offset:0 lds
    s_add_u32 s17, s42, 3072
    buffer_load_dwordx4 v3, s[24:27], s17 offen offset:1024 lds
    s_add_u32 s17, s42, 6144
    buffer_load_dwordx4 v3, s[24:27], s17 offen offset:2048 lds
    s_add_u32 s17, s42, 9216
    buffer_load_dwordx4 v3, s[24:27], s17 offen offset:3072 lds
    s_waitcnt vmcnt(59)
    s_mov_b32 m0, 53248
    s_add_u32 s17, s42, 16384
    buffer_load_dwordx4 v3, s[24:27], s17 offen offset:0 lds
    s_add_u32 s17, s42, 19456
    buffer_load_dwordx4 v3, s[24:27], s17 offen offset:1024 lds
    s_add_u32 s17, s42, 22528
    buffer_load_dwordx4 v3, s[24:27], s17 offen offset:2048 lds
    s_add_u32 s17, s42, 25600
    buffer_load_dwordx4 v3, s[24:27], s17 offen offset:3072 lds
    s_add_u32 s41, s40, 7
    s_and_b32 s41, s41, 15
    s_lshl_b32 s42, s41, 15
    s_waitcnt vmcnt(59)
    s_mov_b32 m0, 57344
    s_add_u32 s17, s42, 0
    buffer_load_dwordx4 v3, s[24:27], s17 offen offset:0 lds
    s_add_u32 s17, s42, 3072
    buffer_load_dwordx4 v3, s[24:27], s17 offen offset:1024 lds
    s_add_u32 s17, s42, 6144
    buffer_load_dwordx4 v3, s[24:27], s17 offen offset:2048 lds
    s_add_u32 s17, s42, 9216
    buffer_load_dwordx4 v3, s[24:27], s17 offen offset:3072 lds
    s_waitcnt vmcnt(59)
    s_mov_b32 m0, 61440
    s_add_u32 s17, s42, 16384
    buffer_load_dwordx4 v3, s[24:27], s17 offen offset:0 lds
    s_add_u32 s17, s42, 19456
    buffer_load_dwordx4 v3, s[24:27], s17 offen offset:1024 lds
    s_add_u32 s17, s42, 22528
    buffer_load_dwordx4 v3, s[24:27], s17 offen offset:2048 lds
    s_add_u32 s17, s42, 25600
    buffer_load_dwordx4 v3, s[24:27], s17 offen offset:3072 lds
    s_waitcnt vmcnt(32)
    s_barrier
    s_add_u32 s41, s40, 8
    s_and_b32 s41, s41, 15
    s_lshl_b32 s42, s41, 15
    s_waitcnt vmcnt(59)
    s_mov_b32 m0, 65536
    s_add_u32 s17, s42, 0
    buffer_load_dwordx4 v3, s[24:27], s17 offen offset:0 lds
    s_add_u32 s17, s42, 3072
    buffer_load_dwordx4 v3, s[24:27], s17 offen offset:1024 lds
    s_add_u32 s17, s42, 6144
    buffer_load_dwordx4 v3, s[24:27], s17 offen offset:2048 lds
    s_add_u32 s17, s42, 9216
    buffer_load_dwordx4 v3, s[24:27], s17 offen offset:3072 lds
    s_waitcnt vmcnt(59)
    s_mov_b32 m0, 69632
    s_add_u32 s17, s42, 16384
    buffer_load_dwordx4 v3, s[24:27], s17 offen offset:0 lds
    s_add_u32 s17, s42, 19456
    buffer_load_dwordx4 v3, s[24:27], s17 offen offset:1024 lds
    s_add_u32 s17, s42, 22528
    buffer_load_dwordx4 v3, s[24:27], s17 offen offset:2048 lds
    s_add_u32 s17, s42, 25600
    buffer_load_dwordx4 v3, s[24:27], s17 offen offset:3072 lds
    s_add_u32 s41, s40, 9
    s_and_b32 s41, s41, 15
    s_lshl_b32 s42, s41, 15
    s_waitcnt vmcnt(59)
    s_mov_b32 m0, 73728
    s_add_u32 s17, s42, 0
    buffer_load_dwordx4 v3, s[24:27], s17 offen offset:0 lds
    s_add_u32 s17, s42, 3072
    buffer_load_dwordx4 v3, s[24:27], s17 offen offset:1024 lds
    s_add_u32 s17, s42, 6144
    buffer_load_dwordx4 v3, s[24:27], s17 offen offset:2048 lds
    s_add_u32 s17, s42, 9216
    buffer_load_dwordx4 v3, s[24:27], s17 offen offset:3072 lds
    s_waitcnt vmcnt(59)
    s_mov_b32 m0, 77824
    s_add_u32 s17, s42, 16384
    buffer_load_dwordx4 v3, s[24:27], s17 offen offset:0 lds
    s_add_u32 s17, s42, 19456
    buffer_load_dwordx4 v3, s[24:27], s17 offen offset:1024 lds
    s_add_u32 s17, s42, 22528
    buffer_load_dwordx4 v3, s[24:27], s17 offen offset:2048 lds
    s_add_u32 s17, s42, 25600
    buffer_load_dwordx4 v3, s[24:27], s17 offen offset:3072 lds
    s_waitcnt vmcnt(32)
    s_barrier
    s_add_u32 s41, s40, 10
    s_and_b32 s41, s41, 15
    s_lshl_b32 s42, s41, 15
    s_waitcnt vmcnt(59)
    s_mov_b32 m0, 81920
    s_add_u32 s17, s42, 0
    buffer_load_dwordx4 v3, s[24:27], s17 offen offset:0 lds
    s_add_u32 s17, s42, 3072
    buffer_load_dwordx4 v3, s[24:27], s17 offen offset:1024 lds
    s_add_u32 s17, s42, 6144
    buffer_load_dwordx4 v3, s[24:27], s17 offen offset:2048 lds
    s_add_u32 s17, s42, 9216
    buffer_load_dwordx4 v3, s[24:27], s17 offen offset:3072 lds
    s_waitcnt vmcnt(59)
    s_mov_b32 m0, 86016
    s_add_u32 s17, s42, 16384
    buffer_load_dwordx4 v3, s[24:27], s17 offen offset:0 lds
    s_add_u32 s17, s42, 19456
    buffer_load_dwordx4 v3, s[24:27], s17 offen offset:1024 lds
    s_add_u32 s17, s42, 22528
    buffer_load_dwordx4 v3, s[24:27], s17 offen offset:2048 lds
    s_add_u32 s17, s42, 25600
    buffer_load_dwordx4 v3, s[24:27], s17 offen offset:3072 lds
    s_add_u32 s41, s40, 11
    s_and_b32 s41, s41, 15
    s_lshl_b32 s42, s41, 15
    s_waitcnt vmcnt(59)
    s_mov_b32 m0, 90112
    s_add_u32 s17, s42, 0
    buffer_load_dwordx4 v3, s[24:27], s17 offen offset:0 lds
    s_add_u32 s17, s42, 3072
    buffer_load_dwordx4 v3, s[24:27], s17 offen offset:1024 lds
    s_add_u32 s17, s42, 6144
    buffer_load_dwordx4 v3, s[24:27], s17 offen offset:2048 lds
    s_add_u32 s17, s42, 9216
    buffer_load_dwordx4 v3, s[24:27], s17 offen offset:3072 lds
    s_waitcnt vmcnt(59)
    s_mov_b32 m0, 94208
    s_add_u32 s17, s42, 16384
    buffer_load_dwordx4 v3, s[24:27], s17 offen offset:0 lds
    s_add_u32 s17, s42, 19456
    buffer_load_dwordx4 v3, s[24:27], s17 offen offset:1024 lds
    s_add_u32 s17, s42, 22528
    buffer_load_dwordx4 v3, s[24:27], s17 offen offset:2048 lds
    s_add_u32 s17, s42, 25600
    buffer_load_dwordx4 v3, s[24:27], s17 offen offset:3072 lds
    s_waitcnt vmcnt(32)
    s_barrier
    s_add_u32 s41, s40, 12
    s_and_b32 s41, s41, 15
    s_lshl_b32 s42, s41, 15
    s_waitcnt vmcnt(59)
    s_mov_b32 m0, 98304
    s_add_u32 s17, s42, 0
    buffer_load_dwordx4 v3, s[24:27], s17 offen offset:0 lds
    s_add_u32 s17, s42, 3072
    buffer_load_dwordx4 v3, s[24:27], s17 offen offset:1024 lds
    s_add_u32 s17, s42, 6144
    buffer_load_dwordx4 v3, s[24:27], s17 offen offset:2048 lds
    s_add_u32 s17, s42, 9216
    buffer_load_dwordx4 v3, s[24:27], s17 offen offset:3072 lds
    s_waitcnt vmcnt(59)
    s_mov_b32 m0, 102400
    s_add_u32 s17, s42, 16384
    buffer_load_dwordx4 v3, s[24:27], s17 offen offset:0 lds
    s_add_u32 s17, s42, 19456
    buffer_load_dwordx4 v3, s[24:27], s17 offen offset:1024 lds
    s_add_u32 s17, s42, 22528
    buffer_load_dwordx4 v3, s[24:27], s17 offen offset:2048 lds
    s_add_u32 s17, s42, 25600
    buffer_load_dwordx4 v3, s[24:27], s17 offen offset:3072 lds
    s_add_u32 s41, s40, 13
    s_and_b32 s41, s41, 15
    s_lshl_b32 s42, s41, 15
    s_waitcnt vmcnt(59)
    s_mov_b32 m0, 106496
    s_add_u32 s17, s42, 0
    buffer_load_dwordx4 v3, s[24:27], s17 offen offset:0 lds
    s_add_u32 s17, s42, 3072
    buffer_load_dwordx4 v3, s[24:27], s17 offen offset:1024 lds
    s_add_u32 s17, s42, 6144
    buffer_load_dwordx4 v3, s[24:27], s17 offen offset:2048 lds
    s_add_u32 s17, s42, 9216
    buffer_load_dwordx4 v3, s[24:27], s17 offen offset:3072 lds
    s_waitcnt vmcnt(59)
    s_mov_b32 m0, 110592
    s_add_u32 s17, s42, 16384
    buffer_load_dwordx4 v3, s[24:27], s17 offen offset:0 lds
    s_add_u32 s17, s42, 19456
    buffer_load_dwordx4 v3, s[24:27], s17 offen offset:1024 lds
    s_add_u32 s17, s42, 22528
    buffer_load_dwordx4 v3, s[24:27], s17 offen offset:2048 lds
    s_add_u32 s17, s42, 25600
    buffer_load_dwordx4 v3, s[24:27], s17 offen offset:3072 lds
    s_waitcnt vmcnt(32)
    s_barrier
    s_add_u32 s41, s40, 14
    s_and_b32 s41, s41, 15
    s_lshl_b32 s42, s41, 15
    s_waitcnt vmcnt(59)
    s_mov_b32 m0, 114688
    s_add_u32 s17, s42, 0
    buffer_load_dwordx4 v3, s[24:27], s17 offen offset:0 lds
    s_add_u32 s17, s42, 3072
    buffer_load_dwordx4 v3, s[24:27], s17 offen offset:1024 lds
    s_add_u32 s17, s42, 6144
    buffer_load_dwordx4 v3, s[24:27], s17 offen offset:2048 lds
    s_add_u32 s17, s42, 9216
    buffer_load_dwordx4 v3, s[24:27], s17 offen offset:3072 lds
    s_waitcnt vmcnt(59)
    s_mov_b32 m0, 118784
    s_add_u32 s17, s42, 16384
    buffer_load_dwordx4 v3, s[24:27], s17 offen offset:0 lds
    s_add_u32 s17, s42, 19456
    buffer_load_dwordx4 v3, s[24:27], s17 offen offset:1024 lds
    s_add_u32 s17, s42, 22528
    buffer_load_dwordx4 v3, s[24:27], s17 offen offset:2048 lds
    s_add_u32 s17, s42, 25600
    buffer_load_dwordx4 v3, s[24:27], s17 offen offset:3072 lds
    s_add_u32 s41, s40, 15
    s_and_b32 s41, s41, 15
    s_lshl_b32 s42, s41, 15
    s_waitcnt vmcnt(59)
    s_mov_b32 m0, 122880
    s_add_u32 s17, s42, 0
    buffer_load_dwordx4 v3, s[24:27], s17 offen offset:0 lds
    s_add_u32 s17, s42, 3072
    buffer_load_dwordx4 v3, s[24:27], s17 offen offset:1024 lds
    s_add_u32 s17, s42, 6144
    buffer_load_dwordx4 v3, s[24:27], s17 offen offset:2048 lds
    s_add_u32 s17, s42, 9216
    buffer_load_dwordx4 v3, s[24:27], s17 offen offset:3072 lds
    s_waitcnt vmcnt(59)
    s_mov_b32 m0, 126976
    s_add_u32 s17, s42, 16384
    buffer_load_dwordx4 v3, s[24:27], s17 offen offset:0 lds
    s_add_u32 s17, s42, 19456
    buffer_load_dwordx4 v3, s[24:27], s17 offen offset:1024 lds
    s_add_u32 s17, s42, 22528
    buffer_load_dwordx4 v3, s[24:27], s17 offen offset:2048 lds
    s_add_u32 s17, s42, 25600
    buffer_load_dwordx4 v3, s[24:27], s17 offen offset:3072 lds
    s_waitcnt vmcnt(32)
    s_barrier
    s_waitcnt vmcnt(16)
    s_barrier
    s_waitcnt vmcnt(0)
    s_barrier
O_END:
    s_endpgm
.globl ored_kernel
.p2align 8
.type ored_kernel,@function
ored_kernel:
    s_cmp_ge_u32 s2, 576
    s_cbranch_scc1 R_END
    s_load_dwordx2 s[4:5], s[0:1], 40
    s_load_dwordx2 s[8:9], s[0:1], 56
    v_lshrrev_b32 v1, 6, v0
    v_and_b32 v0, 63, v0
    s_nop 0
    v_readfirstlane_b32 s16, v1
    s_waitcnt lgkmcnt(0)
    s_lshl_b32 s17, s2, 2
    s_add_u32 s17, s17, s16
    s_and_b32 s18, s17, 7
    s_lshr_b32 s19, s17, 3
    s_lshl_b32 s20, s17, 10
    s_add_u32 s21, s20, 16777216
    s_sub_u32 s22, 18874368, s20
    s_add_u32 s24, s8, s21
    s_addc_u32 s25, s9, 0
    s_and_b32 s25, s25, 0xffff
    s_mov_b32 s26, s22
    s_mov_b32 s27, 0x00020000
    v_lshlrev_b32 v3, 4, v0
    s_mov_b32 s32, 0
    buffer_load_dwordx4 v[8:11], v3, s[24:27], s32 offen
    s_mov_b32 s33, 2359296
    buffer_load_dwordx4 v[12:15], v3, s[24:27], s33 offen
    s_mov_b32 s34, 4718592
    buffer_load_dwordx4 v[16:19], v3, s[24:27], s34 offen
    s_mov_b32 s35, 7077888
    buffer_load_dwordx4 v[20:23], v3, s[24:27], s35 offen
    s_mov_b32 s36, 9437184
    buffer_load_dwordx4 v[24:27], v3, s[24:27], s36 offen
    s_mov_b32 s37, 11796480
    buffer_load_dwordx4 v[28:31], v3, s[24:27], s37 offen
    s_mov_b32 s38, 14155776
    buffer_load_dwordx4 v[32:35], v3, s[24:27], s38 offen
    s_mov_b32 s39, 16515072
    buffer_load_dwordx4 v[36:39], v3, s[24:27], s39 offen
    s_lshr_b32 s20, s19, 2
    s_lshl_b32 s20, s20, 14
    s_and_b32 s21, s19, 3
    s_lshl_b32 s21, s21, 8
    s_add_u32 s20, s20, s21
    s_lshl_b32 s21, s18, 3
    s_add_u32 s20, s20, s21
    s_sub_u32 s22, 1179648, s20
    s_add_u32 s28, s4, s20
    s_addc_u32 s29, s5, 0
    s_and_b32 s29, s29, 0xffff
    s_mov_b32 s30, s22
    s_mov_b32 s31, 0x00020000
    v_lshrrev_b32 v1, 4, v0
    v_and_b32 v2, 15, v0
    v_lshlrev_b32 v4, 10, v2
    v_lshl_add_u32 v4, v1, 6, v4
    s_waitcnt vmcnt(6)
    v_add_f32 v8, v8, v12
    v_add_f32 v9, v9, v13
    v_add_f32 v10, v10, v14
    v_add_f32 v11, v11, v15
    s_waitcnt vmcnt(5)
    v_add_f32 v8, v8, v16
    v_add_f32 v9, v9, v17
    v_add_f32 v10, v10, v18
    v_add_f32 v11, v11, v19
    s_waitcnt vmcnt(4)
    v_add_f32 v8, v8, v20
    v_add_f32 v9, v9, v21
    v_add_f32 v10, v10, v22
    v_add_f32 v11, v11, v23
    s_waitcnt vmcnt(3)
    v_add_f32 v8, v8, v24
    v_add_f32 v9, v9, v25
    v_add_f32 v10, v10, v26
    v_add_f32 v11, v11, v27
    s_waitcnt vmcnt(2)
    v_add_f32 v8, v8, v28
    v_add_f32 v9, v9, v29
    v_add_f32 v10, v10, v30
    v_add_f32 v11, v11, v31
    s_waitcnt vmcnt(1)
    v_add_f32 v8, v8, v32
    v_add_f32 v9, v9, v33
    v_add_f32 v10, v10, v34
    v_add_f32 v11, v11, v35
    s_waitcnt vmcnt(0)
    v_add_f32 v8, v8, v36
    v_add_f32 v9, v9, v37
    v_add_f32 v10, v10, v38
    v_add_f32 v11, v11, v39
    v_cvt_pk_bf16_f32 v6, v8, v9
    v_cvt_pk_bf16_f32 v7, v10, v11
    buffer_store_dwordx2 v[6:7], v4, s[28:31], 0 offen
R_END:
    s_endpgm
.section .rodata,"a"
.p2align 6
.amdhsa_kernel attn_kernel
  .amdhsa_next_free_vgpr 480
  .amdhsa_next_free_sgpr 96
  .amdhsa_accum_offset 256
  .amdhsa_group_segment_fixed_size 0
  .amdhsa_kernarg_size 64
  .amdhsa_user_sgpr_count 2
  .amdhsa_user_sgpr_kernarg_segment_ptr 1
  .amdhsa_system_sgpr_workgroup_id_x 1
.end_amdhsa_kernel
.p2align 6
.amdhsa_kernel oproj_kernel
  .amdhsa_next_free_vgpr 512
  .amdhsa_next_free_sgpr 96
  .amdhsa_accum_offset 256
  .amdhsa_group_segment_fixed_size 0
  .amdhsa_kernarg_size 64
  .amdhsa_user_sgpr_count 2
  .amdhsa_user_sgpr_kernarg_segment_ptr 1
  .amdhsa_system_sgpr_workgroup_id_x 1
.end_amdhsa_kernel
.p2align 6
.amdhsa_kernel ored_kernel
  .amdhsa_next_free_vgpr 40
  .amdhsa_next_free_sgpr 96
  .amdhsa_accum_offset 40
  .amdhsa_group_segment_fixed_size 0
  .amdhsa_kernarg_size 64
  .amdhsa_user_sgpr_count 2
  .amdhsa_user_sgpr_kernarg_segment_ptr 1
  .amdhsa_system_sgpr_workgroup_id_x 1
.end_amdhsa_kernel
```
